```python
import torch

def _softmax(x, axis=-1):
    return torch.softmax(x, dim=axis)
def _gelu(x):
    return torch.nn.functional.gelu(x, approximate="tanh")
def _silu(x):
    return torch.nn.functional.silu(x)
def _sigmoid(x):
    return torch.sigmoid(x)
def _layernorm(x, axis=-1, eps=1e-5):
    m = x.mean(dim=axis, keepdim=True)
    v = x.var(dim=axis, keepdim=True, unbiased=False)
    return (x - m) / torch.sqrt(v + eps)
def _scatter_add(tgt, idx, src, axis=0):
    return tgt.clone().index_add_(axis, idx, src)
def _segment_sum(src, seg, n):
    out = torch.zeros((n,) + src.shape[1:], dtype=src.dtype)
    return out.index_add_(0, seg, src)
def _pad(x, pw):
    flat = tuple(v for pair in reversed(pw) for v in pair)
    return torch.nn.functional.pad(x, flat)

kernel_name = 'standalone__gated_linear_recurrence__prompt'

def setup_inputs():

    _w = (lambda a: (lambda t: t.to(torch.bfloat16) if t.is_floating_point() else t)(torch.as_tensor(a)))
    B, H, T, D = 1, 32, 2048, 128
    return {
        "q": _w((lambda *s: torch.randn(*s, dtype=torch.bfloat16) * 0.05)(B, H, T, D)),
        "k": _w((lambda *s: torch.randn(*s, dtype=torch.bfloat16) * 0.05)(B, H, T, D)),
        "v": _w((lambda *s: torch.randn(*s, dtype=torch.bfloat16) * 0.05)(B, H, T, D)),
        "g": _w((lambda *s: torch.randn(*s, dtype=torch.bfloat16) * 0.8)(B, H, T, D)),
    }

def reference(q, k, v, g):
    B, H, T, D = q.shape
    scale = D ** -0.5
    a = _sigmoid(g)
    S = k[:, :, 0, :, None] * v[:, :, 0, None, :] * 0.0
    outs = []
    for t in range(T):
        S = a[:, :, t, :, None] * S + k[:, :, t, :, None] * v[:, :, t, None, :]
        ot = torch.einsum("bhd,bhde->bhe", q[:, :, t, :], S) * scale
        outs.append(ot)
    return torch.stack(outs, 2)
```

```asm
; @launch grid=(256,1,1) block=(512,1,1) lds=160000
.amdgcn_target "amdgcn-amd-amdhsa--gfx950"
.text
.globl standalone__gated_linear_recurrence__prompt_kernel
.p2align 8
.type standalone__gated_linear_recurrence__prompt_kernel,@function
standalone__gated_linear_recurrence__prompt_kernel:
    s_cmp_ge_u32 s2, 256
    s_cbranch_scc1 L_end
    s_load_dwordx8 s[16:23], s[0:1], 0
    s_load_dwordx4 s[24:27], s[0:1], 32
    s_load_dwordx2 s[28:29], s[0:1], 48
    s_memrealtime s[80:81]
    v_lshrrev_b32 v4, 6, v0
    v_and_b32 v0, 63, v0
    v_readfirstlane_b32 s5, v4
    v_lshrrev_b32 v5, 4, v0
    v_and_b32 v4, 7, v0
    v_xor_b32 v4, v4, v5
    v_lshlrev_b32 v1, 4, v4
    v_lshrrev_b32 v4, 3, v0
    v_lshl_add_u32 v1, v4, 9, v1
    v_xor_b32 v2, 64, v1
    v_add_u32 v2, 4096, v2
    s_getreg_b32 s15, hwreg(HW_REG_XCC_ID, 0, 3)
    v_mov_b32 v255, 151552
    s_waitcnt lgkmcnt(0)
    s_mov_b32 s52, s26
    s_and_b32 s53, s27, 0xffff
    s_mov_b32 s54, 256
    s_mov_b32 s55, 0x00020000
    s_mov_b32 s44, s22
    s_and_b32 s45, s23, 0xffff
    s_mov_b32 s46, 16777216
    s_mov_b32 s47, 0x00020000
    s_mov_b32 s36, s18
    s_and_b32 s37, s19, 0xffff
    s_mov_b32 s38, 16777216
    s_mov_b32 s39, 0x00020000
    s_and_b32 s3, s2, 31
    s_lshr_b32 s4, s2, 5
    s_lshl_b32 s62, s3, 19
    s_lshl_b32 s82, s4, 16
    s_add_u32 s62, s62, s82
    s_lshl_b32 s60, s5, 13
    s_add_u32 s6, s62, s60
    s_add_u32 s61, s60, 65536
    s_add_u32 s62, s62, 24576
    s_lshl_b32 s7, s3, 3
    s_add_u32 s7, s7, s4
    s_lshl_b32 s7, s7, 3
    s_add_u32 s7, s7, s5
    s_add_u32 m0, s61, 0
    s_nop 0
    buffer_load_dwordx4 v1, s[44:47], s6 offen offset:0 nt lds
    s_add_u32 m0, s61, 1024
    s_nop 0
    buffer_load_dwordx4 v2, s[44:47], s6 offen offset:0 nt lds
    s_add_u32 m0, s61, 1792
    s_nop 0
    buffer_load_dwordx4 v1, s[44:47], s6 offen offset:256 nt lds
    s_add_u32 m0, s61, 2816
    s_nop 0
    buffer_load_dwordx4 v2, s[44:47], s6 offen offset:256 nt lds
    s_add_u32 m0, s60, 0
    s_nop 0
    buffer_load_dwordx4 v1, s[36:39], s6 offen offset:0 nt lds
    s_mov_b32 s32, s16
    s_and_b32 s33, s17, 0xffff
    s_mov_b32 s34, 16777216
    s_mov_b32 s35, 0x00020000
    s_mov_b32 s40, s20
    s_and_b32 s41, s21, 0xffff
    s_mov_b32 s42, 16777216
    s_mov_b32 s43, 0x00020000
    s_mov_b32 s48, s24
    s_and_b32 s49, s25, 0xffff
    s_mov_b32 s50, 16777216
    s_mov_b32 s51, 0x00020000
    s_mov_b32 s56, s28
    s_and_b32 s57, s29, 0xffff
    s_mov_b32 s58, 268435456
    s_mov_b32 s59, 0x00020000
    s_or_b32 s14, s80, 1
    s_lshl_b32 s15, s15, 2
    s_lshl_b32 s15, 1, s15
    v_mov_b32 v253, s15
    s_lshl_b32 s82, s3, 2
    s_mov_b64 exec, 1
    s_cmp_lg_u32 s5, 0
    s_cbranch_scc1 L_noreg
    buffer_atomic_add v253, off, s[52:55], s82 offset:128 sc1
    s_branch L_regdone
L_noreg:
    buffer_load_dword v253, off, s[36:39], s6
L_regdone:
    s_mov_b64 exec, -1
    s_lshl_b32 s15, s15, 3
    s_mov_b32 s8, 0xbfb8aa3b
    s_mov_b32 s10, 1.0
    s_mov_b32 s12, 0x3db504f3
    s_mov_b32 s9, 0xbfb8aa3b
    s_mov_b32 s11, 1.0
    s_mov_b32 s13, 0x3db504f3
    s_lshl_b32 s82, s5, 1
    s_and_b32 s82, s82, 4
    v_bfe_u32 v4, v0, 1, 3
    v_xor_b32 v4, v4, v5
    v_xor_b32 v4, s82, v4
    v_lshlrev_b32 v3, 5, v4
    v_and_b32 v4, 1, v0
    v_lshl_add_u32 v3, v4, 4, v3
    v_lshl_add_u32 v3, v5, 8, v3
    s_lshl_b32 s82, s5, 10
    v_add_u32 v3, s82, v3
    v_lshlrev_b32 v7, 4, v0
    v_and_b32 v4, 15, v0
    v_lshrrev_b32 v192, 1, v4
    v_xor_b32 v192, v192, v5
    v_lshlrev_b32 v192, 4, v192
    v_lshl_add_u32 v192, v4, 7, v192
    v_add_u32 v14, s60, v192
    v_xor_b32 v15, 64, v14
    v_add_u32 v12, 65536, v14
    v_add_u32 v13, 65536, v15
    v_and_b32 v192, 1, v4
    v_lshlrev_b32 v192, 7, v192
    v_lshrrev_b32 v193, 1, v4
    v_lshl_add_u32 v192, v193, 9, v192
    v_and_b32 v193, 3, v193
    v_lshl_add_u32 v192, v193, 5, v192
    v_lshl_add_u32 v192, v5, 3, v192
    v_add_u32 v8, s60, v192
    v_xor_b32 v9, 32, v8
    v_xor_b32 v10, 64, v8
    v_xor_b32 v11, 96, v8
    v_bfe_u32 v192, v0, 3, 1
    v_lshlrev_b32 v240, 7, v192
    v_bfe_u32 v192, v0, 2, 1
    v_lshl_add_u32 v240, v192, 8, v240
    v_lshl_add_u32 v240, v5, 10, v240
    v_bfe_u32 v193, v0, 4, 1
    v_lshl_or_b32 v192, v193, 1, v192
    v_lshl_add_u32 v240, v192, 5, v240
    v_and_b32 v192, 3, v0
    v_lshl_add_u32 v240, v192, 3, v240
    v_add_u32 v240, s60, v240
    v_xor_b32 v241, 32, v240
    v_xor_b32 v242, 64, v240
    v_xor_b32 v243, 96, v240
    v_add_u32 v244, s60, v7
    v_lshlrev_b32 v192, 2, v5
    v_add_u32 v193, 0, v192
    v_cmp_lt_u32 s[64:65], v193, v4
    v_cmp_le_u32 s[72:73], v193, v4
    v_add_u32 v193, 1, v192
    v_cmp_lt_u32 s[66:67], v193, v4
    v_cmp_le_u32 s[74:75], v193, v4
    v_add_u32 v193, 2, v192
    v_cmp_lt_u32 s[68:69], v193, v4
    v_cmp_le_u32 s[76:77], v193, v4
    v_add_u32 v193, 3, v192
    v_cmp_lt_u32 s[70:71], v193, v4
    v_cmp_le_u32 s[78:79], v193, v4
    s_lshl_b32 s82, s5, 9
    s_add_u32 s82, s82, 147456
    v_lshlrev_b32 v5, 7, v5
    v_add_u32 v5, s82, v5
    v_mov_b32 v6, 1.0
    s_waitcnt vmcnt(5)
    s_add_u32 m0, s60, 1024
    s_nop 0
    buffer_load_dwordx4 v2, s[36:39], s6 offen offset:0 nt lds
    s_waitcnt vmcnt(5)
    s_add_u32 m0, s60, 1792
    s_nop 0
    buffer_load_dwordx4 v1, s[36:39], s6 offen offset:256 nt lds
    s_waitcnt vmcnt(5)
    s_add_u32 m0, s60, 2816
    s_nop 0
    buffer_load_dwordx4 v2, s[36:39], s6 offen offset:256 nt lds
    s_waitcnt vmcnt(5)
    s_add_u32 m0, s61, 3968
    s_nop 0
    buffer_load_dwordx4 v1, s[44:47], s6 offen offset:128 nt lds
    ds_read_b128 v[112:115], v12 offset:0
    ds_read_b128 v[116:119], v12 offset:2048
    ds_read_b128 v[120:123], v13 offset:0
    ds_read_b128 v[124:127], v13 offset:2048
    s_waitcnt lgkmcnt(3)
    v_lshlrev_b32 v144, 16, v112
    v_and_b32 v145, 0xffff0000, v112
    v_lshlrev_b32 v146, 16, v113
    v_and_b32 v147, 0xffff0000, v113
    v_lshlrev_b32 v148, 16, v114
    v_and_b32 v149, 0xffff0000, v114
    v_lshlrev_b32 v150, 16, v115
    v_and_b32 v151, 0xffff0000, v115
    s_waitcnt lgkmcnt(2)
    v_lshlrev_b32 v192, 16, v116
    v_and_b32 v193, 0xffff0000, v116
    v_lshlrev_b32 v194, 16, v117
    v_and_b32 v195, 0xffff0000, v117
    v_lshlrev_b32 v196, 16, v118
    v_and_b32 v197, 0xffff0000, v118
    v_lshlrev_b32 v198, 16, v119
    v_and_b32 v199, 0xffff0000, v119
    v_pk_mul_f32 v[144:145], v[144:145], s[8:9]
    v_pk_mul_f32 v[146:147], v[146:147], s[8:9]
    v_pk_mul_f32 v[148:149], v[148:149], s[8:9]
    v_pk_mul_f32 v[150:151], v[150:151], s[8:9]
    v_pk_mul_f32 v[192:193], v[192:193], s[8:9]
    v_pk_mul_f32 v[194:195], v[194:195], s[8:9]
    v_pk_mul_f32 v[196:197], v[196:197], s[8:9]
    v_pk_mul_f32 v[198:199], v[198:199], s[8:9]
    v_exp_f32 v144, v144
    v_exp_f32 v192, v192
    v_exp_f32 v145, v145
    v_exp_f32 v193, v193
    v_exp_f32 v146, v146
    v_exp_f32 v194, v194
    v_exp_f32 v147, v147
    v_exp_f32 v195, v195
    v_exp_f32 v148, v148
    v_exp_f32 v196, v196
    v_exp_f32 v149, v149
    v_exp_f32 v197, v197
    v_exp_f32 v150, v150
    v_exp_f32 v198, v198
    v_exp_f32 v151, v151
    v_exp_f32 v199, v199
    v_pk_add_f32 v[144:145], v[144:145], s[10:11]
    v_pk_add_f32 v[146:147], v[146:147], s[10:11]
    v_pk_add_f32 v[148:149], v[148:149], s[10:11]
    v_pk_add_f32 v[150:151], v[150:151], s[10:11]
    v_pk_add_f32 v[192:193], v[192:193], s[10:11]
    v_pk_add_f32 v[194:195], v[194:195], s[10:11]
    v_pk_add_f32 v[196:197], v[196:197], s[10:11]
    v_pk_add_f32 v[198:199], v[198:199], s[10:11]
    v_pk_mul_f32 v[152:153], v[144:145], v[192:193]
    v_pk_mul_f32 v[154:155], v[146:147], v[194:195]
    v_pk_mul_f32 v[156:157], v[148:149], v[196:197]
    v_pk_mul_f32 v[158:159], v[150:151], v[198:199]
    v_mul_f32_dpp v152, v152, v152 row_shr:1 row_mask:0xf bank_mask:0xf
    v_mul_f32_dpp v153, v153, v153 row_shr:1 row_mask:0xf bank_mask:0xf
    v_mul_f32_dpp v154, v154, v154 row_shr:1 row_mask:0xf bank_mask:0xf
    v_mul_f32_dpp v155, v155, v155 row_shr:1 row_mask:0xf bank_mask:0xf
    v_mul_f32_dpp v156, v156, v156 row_shr:1 row_mask:0xf bank_mask:0xf
    v_mul_f32_dpp v157, v157, v157 row_shr:1 row_mask:0xf bank_mask:0xf
    v_mul_f32_dpp v158, v158, v158 row_shr:1 row_mask:0xf bank_mask:0xf
    v_mul_f32_dpp v159, v159, v159 row_shr:1 row_mask:0xf bank_mask:0xf
    v_mul_f32_dpp v152, v152, v152 row_shr:2 row_mask:0xf bank_mask:0xf
    v_mul_f32_dpp v153, v153, v153 row_shr:2 row_mask:0xf bank_mask:0xf
    v_mul_f32_dpp v154, v154, v154 row_shr:2 row_mask:0xf bank_mask:0xf
    v_mul_f32_dpp v155, v155, v155 row_shr:2 row_mask:0xf bank_mask:0xf
    v_mul_f32_dpp v156, v156, v156 row_shr:2 row_mask:0xf bank_mask:0xf
    v_mul_f32_dpp v157, v157, v157 row_shr:2 row_mask:0xf bank_mask:0xf
    v_mul_f32_dpp v158, v158, v158 row_shr:2 row_mask:0xf bank_mask:0xf
    v_mul_f32_dpp v159, v159, v159 row_shr:2 row_mask:0xf bank_mask:0xf
    v_mul_f32_dpp v152, v152, v152 row_shr:4 row_mask:0xf bank_mask:0xf
    v_mul_f32_dpp v153, v153, v153 row_shr:4 row_mask:0xf bank_mask:0xf
    v_mul_f32_dpp v154, v154, v154 row_shr:4 row_mask:0xf bank_mask:0xf
    v_mul_f32_dpp v155, v155, v155 row_shr:4 row_mask:0xf bank_mask:0xf
    v_mul_f32_dpp v156, v156, v156 row_shr:4 row_mask:0xf bank_mask:0xf
    v_mul_f32_dpp v157, v157, v157 row_shr:4 row_mask:0xf bank_mask:0xf
    v_mul_f32_dpp v158, v158, v158 row_shr:4 row_mask:0xf bank_mask:0xf
    v_mul_f32_dpp v159, v159, v159 row_shr:4 row_mask:0xf bank_mask:0xf
    v_mul_f32_dpp v152, v152, v152 row_shr:8 row_mask:0xf bank_mask:0xf
    v_mul_f32_dpp v153, v153, v153 row_shr:8 row_mask:0xf bank_mask:0xf
    v_mul_f32_dpp v154, v154, v154 row_shr:8 row_mask:0xf bank_mask:0xf
    v_mul_f32_dpp v155, v155, v155 row_shr:8 row_mask:0xf bank_mask:0xf
    v_mul_f32_dpp v156, v156, v156 row_shr:8 row_mask:0xf bank_mask:0xf
    v_mul_f32_dpp v157, v157, v157 row_shr:8 row_mask:0xf bank_mask:0xf
    v_mul_f32_dpp v158, v158, v158 row_shr:8 row_mask:0xf bank_mask:0xf
    v_mul_f32_dpp v159, v159, v159 row_shr:8 row_mask:0xf bank_mask:0xf
    v_mul_f32_dpp v144, v152, v144 row_shr:1 row_mask:0xf bank_mask:0xf
    v_mul_f32_dpp v145, v153, v145 row_shr:1 row_mask:0xf bank_mask:0xf
    v_mul_f32_dpp v146, v154, v146 row_shr:1 row_mask:0xf bank_mask:0xf
    v_mul_f32_dpp v147, v155, v147 row_shr:1 row_mask:0xf bank_mask:0xf
    v_mul_f32_dpp v148, v156, v148 row_shr:1 row_mask:0xf bank_mask:0xf
    v_mul_f32_dpp v149, v157, v149 row_shr:1 row_mask:0xf bank_mask:0xf
    v_mul_f32_dpp v150, v158, v150 row_shr:1 row_mask:0xf bank_mask:0xf
    v_mul_f32_dpp v151, v159, v151 row_shr:1 row_mask:0xf bank_mask:0xf
    v_rcp_f32 v24, v152
    v_rcp_f32 v25, v153
    v_rcp_f32 v26, v154
    v_rcp_f32 v27, v155
    v_rcp_f32 v28, v156
    v_rcp_f32 v29, v157
    v_rcp_f32 v30, v158
    v_rcp_f32 v31, v159
    v_max3_f32 v6, v6, v152, v153
    v_max3_f32 v6, v6, v154, v155
    v_max3_f32 v6, v6, v156, v157
    v_max3_f32 v6, v6, v158, v159
    v_pk_mul_f32 v[16:17], v[24:25], v[192:193]
    v_pk_mul_f32 v[18:19], v[26:27], v[194:195]
    v_pk_mul_f32 v[20:21], v[28:29], v[196:197]
    v_pk_mul_f32 v[22:23], v[30:31], v[198:199]
    s_mov_b32 exec_lo, 0x80008000
    s_mov_b32 exec_hi, 0x80008000
    ds_write_b128 v5, v[24:27] offset:0
    ds_write_b128 v5, v[28:31] offset:16
    s_mov_b64 exec, -1
    s_waitcnt lgkmcnt(3)
    v_lshlrev_b32 v160, 16, v120
    v_and_b32 v161, 0xffff0000, v120
    v_lshlrev_b32 v162, 16, v121
    v_and_b32 v163, 0xffff0000, v121
    v_lshlrev_b32 v164, 16, v122
    v_and_b32 v165, 0xffff0000, v122
    v_lshlrev_b32 v166, 16, v123
    v_and_b32 v167, 0xffff0000, v123
    s_waitcnt lgkmcnt(2)
    v_lshlrev_b32 v192, 16, v124
    v_and_b32 v193, 0xffff0000, v124
    v_lshlrev_b32 v194, 16, v125
    v_and_b32 v195, 0xffff0000, v125
    v_lshlrev_b32 v196, 16, v126
    v_and_b32 v197, 0xffff0000, v126
    v_lshlrev_b32 v198, 16, v127
    v_and_b32 v199, 0xffff0000, v127
    v_pk_mul_f32 v[160:161], v[160:161], s[8:9]
    v_pk_mul_f32 v[162:163], v[162:163], s[8:9]
    v_pk_mul_f32 v[164:165], v[164:165], s[8:9]
    v_pk_mul_f32 v[166:167], v[166:167], s[8:9]
    v_pk_mul_f32 v[192:193], v[192:193], s[8:9]
    v_pk_mul_f32 v[194:195], v[194:195], s[8:9]
    v_pk_mul_f32 v[196:197], v[196:197], s[8:9]
    v_pk_mul_f32 v[198:199], v[198:199], s[8:9]
    v_exp_f32 v160, v160
    v_exp_f32 v192, v192
    v_exp_f32 v161, v161
    v_exp_f32 v193, v193
    v_exp_f32 v162, v162
    v_exp_f32 v194, v194
    v_exp_f32 v163, v163
    v_exp_f32 v195, v195
    v_exp_f32 v164, v164
    v_exp_f32 v196, v196
    v_exp_f32 v165, v165
    v_exp_f32 v197, v197
    v_exp_f32 v166, v166
    v_exp_f32 v198, v198
    v_exp_f32 v167, v167
    v_exp_f32 v199, v199
    v_pk_add_f32 v[160:161], v[160:161], s[10:11]
    v_pk_add_f32 v[162:163], v[162:163], s[10:11]
    v_pk_add_f32 v[164:165], v[164:165], s[10:11]
    v_pk_add_f32 v[166:167], v[166:167], s[10:11]
    v_pk_add_f32 v[192:193], v[192:193], s[10:11]
    v_pk_add_f32 v[194:195], v[194:195], s[10:11]
    v_pk_add_f32 v[196:197], v[196:197], s[10:11]
    v_pk_add_f32 v[198:199], v[198:199], s[10:11]
    v_pk_mul_f32 v[168:169], v[160:161], v[192:193]
    v_pk_mul_f32 v[170:171], v[162:163], v[194:195]
    v_pk_mul_f32 v[172:173], v[164:165], v[196:197]
    v_pk_mul_f32 v[174:175], v[166:167], v[198:199]
    v_mul_f32_dpp v168, v168, v168 row_shr:1 row_mask:0xf bank_mask:0xf
    v_mul_f32_dpp v169, v169, v169 row_shr:1 row_mask:0xf bank_mask:0xf
    v_mul_f32_dpp v170, v170, v170 row_shr:1 row_mask:0xf bank_mask:0xf
    v_mul_f32_dpp v171, v171, v171 row_shr:1 row_mask:0xf bank_mask:0xf
    v_mul_f32_dpp v172, v172, v172 row_shr:1 row_mask:0xf bank_mask:0xf
    v_mul_f32_dpp v173, v173, v173 row_shr:1 row_mask:0xf bank_mask:0xf
    v_mul_f32_dpp v174, v174, v174 row_shr:1 row_mask:0xf bank_mask:0xf
    v_mul_f32_dpp v175, v175, v175 row_shr:1 row_mask:0xf bank_mask:0xf
    v_mul_f32_dpp v168, v168, v168 row_shr:2 row_mask:0xf bank_mask:0xf
    v_mul_f32_dpp v169, v169, v169 row_shr:2 row_mask:0xf bank_mask:0xf
    v_mul_f32_dpp v170, v170, v170 row_shr:2 row_mask:0xf bank_mask:0xf
    v_mul_f32_dpp v171, v171, v171 row_shr:2 row_mask:0xf bank_mask:0xf
    v_mul_f32_dpp v172, v172, v172 row_shr:2 row_mask:0xf bank_mask:0xf
    v_mul_f32_dpp v173, v173, v173 row_shr:2 row_mask:0xf bank_mask:0xf
    v_mul_f32_dpp v174, v174, v174 row_shr:2 row_mask:0xf bank_mask:0xf
    v_mul_f32_dpp v175, v175, v175 row_shr:2 row_mask:0xf bank_mask:0xf
    v_mul_f32_dpp v168, v168, v168 row_shr:4 row_mask:0xf bank_mask:0xf
    v_mul_f32_dpp v169, v169, v169 row_shr:4 row_mask:0xf bank_mask:0xf
    v_mul_f32_dpp v170, v170, v170 row_shr:4 row_mask:0xf bank_mask:0xf
    v_mul_f32_dpp v171, v171, v171 row_shr:4 row_mask:0xf bank_mask:0xf
    v_mul_f32_dpp v172, v172, v172 row_shr:4 row_mask:0xf bank_mask:0xf
    v_mul_f32_dpp v173, v173, v173 row_shr:4 row_mask:0xf bank_mask:0xf
    v_mul_f32_dpp v174, v174, v174 row_shr:4 row_mask:0xf bank_mask:0xf
    v_mul_f32_dpp v175, v175, v175 row_shr:4 row_mask:0xf bank_mask:0xf
    v_mul_f32_dpp v168, v168, v168 row_shr:8 row_mask:0xf bank_mask:0xf
    v_mul_f32_dpp v169, v169, v169 row_shr:8 row_mask:0xf bank_mask:0xf
    v_mul_f32_dpp v170, v170, v170 row_shr:8 row_mask:0xf bank_mask:0xf
    v_mul_f32_dpp v171, v171, v171 row_shr:8 row_mask:0xf bank_mask:0xf
    v_mul_f32_dpp v172, v172, v172 row_shr:8 row_mask:0xf bank_mask:0xf
    v_mul_f32_dpp v173, v173, v173 row_shr:8 row_mask:0xf bank_mask:0xf
    v_mul_f32_dpp v174, v174, v174 row_shr:8 row_mask:0xf bank_mask:0xf
    v_mul_f32_dpp v175, v175, v175 row_shr:8 row_mask:0xf bank_mask:0xf
    v_mul_f32_dpp v160, v168, v160 row_shr:1 row_mask:0xf bank_mask:0xf
    v_mul_f32_dpp v161, v169, v161 row_shr:1 row_mask:0xf bank_mask:0xf
    v_mul_f32_dpp v162, v170, v162 row_shr:1 row_mask:0xf bank_mask:0xf
    v_mul_f32_dpp v163, v171, v163 row_shr:1 row_mask:0xf bank_mask:0xf
    v_mul_f32_dpp v164, v172, v164 row_shr:1 row_mask:0xf bank_mask:0xf
    v_mul_f32_dpp v165, v173, v165 row_shr:1 row_mask:0xf bank_mask:0xf
    v_mul_f32_dpp v166, v174, v166 row_shr:1 row_mask:0xf bank_mask:0xf
    v_mul_f32_dpp v167, v175, v167 row_shr:1 row_mask:0xf bank_mask:0xf
    v_rcp_f32 v40, v168
    v_rcp_f32 v41, v169
    v_rcp_f32 v42, v170
    v_rcp_f32 v43, v171
    v_rcp_f32 v44, v172
    v_rcp_f32 v45, v173
    v_rcp_f32 v46, v174
    v_rcp_f32 v47, v175
    v_max3_f32 v6, v6, v168, v169
    v_max3_f32 v6, v6, v170, v171
    v_max3_f32 v6, v6, v172, v173
    v_max3_f32 v6, v6, v174, v175
    v_pk_mul_f32 v[32:33], v[40:41], v[192:193]
    v_pk_mul_f32 v[34:35], v[42:43], v[194:195]
    v_pk_mul_f32 v[36:37], v[44:45], v[196:197]
    v_pk_mul_f32 v[38:39], v[46:47], v[198:199]
    s_mov_b32 exec_lo, 0x80008000
    s_mov_b32 exec_hi, 0x80008000
    ds_write_b128 v5, v[40:43] offset:32
    ds_write_b128 v5, v[44:47] offset:48
    s_mov_b64 exec, -1
    s_waitcnt vmcnt(5)
    s_add_u32 m0, s61, 4992
    s_nop 0
    buffer_load_dwordx4 v2, s[44:47], s6 offen offset:128 nt lds
    s_waitcnt vmcnt(4)
    s_add_u32 m0, s61, 5760
    s_nop 0
    buffer_load_dwordx4 v1, s[44:47], s6 offen offset:384 nt lds
    s_waitcnt vmcnt(4)
    s_add_u32 m0, s61, 6784
    s_nop 0
    buffer_load_dwordx4 v2, s[44:47], s6 offen offset:384 nt lds
    s_waitcnt vmcnt(4)
    s_add_u32 m0, s60, 3968
    s_nop 0
    buffer_load_dwordx4 v1, s[36:39], s6 offen offset:128 nt lds
    ds_read_b128 v[112:115], v14 offset:0
    ds_read_b128 v[116:119], v14 offset:2048
    ds_read_b128 v[120:123], v15 offset:0
    ds_read_b128 v[124:127], v15 offset:2048
    s_waitcnt lgkmcnt(0)
    v_lshlrev_b32 v200, 16, v112
    v_and_b32 v201, 0xffff0000, v112
    v_lshlrev_b32 v202, 16, v113
    v_and_b32 v203, 0xffff0000, v113
    v_lshlrev_b32 v204, 16, v114
    v_and_b32 v205, 0xffff0000, v114
    v_lshlrev_b32 v206, 16, v115
    v_and_b32 v207, 0xffff0000, v115
    v_lshlrev_b32 v208, 16, v116
    v_and_b32 v209, 0xffff0000, v116
    v_lshlrev_b32 v210, 16, v117
    v_and_b32 v211, 0xffff0000, v117
    v_lshlrev_b32 v212, 16, v118
    v_and_b32 v213, 0xffff0000, v118
    v_lshlrev_b32 v214, 16, v119
    v_and_b32 v215, 0xffff0000, v119
    v_pk_mul_f32 v[200:201], v[200:201], s[12:13]
    v_pk_mul_f32 v[202:203], v[202:203], s[12:13]
    v_pk_mul_f32 v[204:205], v[204:205], s[12:13]
    v_pk_mul_f32 v[206:207], v[206:207], s[12:13]
    v_pk_mul_f32 v[208:209], v[208:209], s[12:13]
    v_pk_mul_f32 v[210:211], v[210:211], s[12:13]
    v_pk_mul_f32 v[212:213], v[212:213], s[12:13]
    v_pk_mul_f32 v[214:215], v[214:215], s[12:13]
    v_pk_mul_f32 v[200:201], v[200:201], v[144:145]
    v_pk_mul_f32 v[202:203], v[202:203], v[146:147]
    v_pk_mul_f32 v[204:205], v[204:205], v[148:149]
    v_pk_mul_f32 v[206:207], v[206:207], v[150:151]
    v_pk_mul_f32 v[208:209], v[208:209], v[152:153]
    v_pk_mul_f32 v[210:211], v[210:211], v[154:155]
    v_pk_mul_f32 v[212:213], v[212:213], v[156:157]
    v_pk_mul_f32 v[214:215], v[214:215], v[158:159]
    v_max3_f32 v6, v6, |v200|, |v201|
    v_max3_f32 v6, v6, |v202|, |v203|
    v_max3_f32 v6, v6, |v204|, |v205|
    v_max3_f32 v6, v6, |v206|, |v207|
    v_max3_f32 v6, v6, |v208|, |v209|
    v_max3_f32 v6, v6, |v210|, |v211|
    v_max3_f32 v6, v6, |v212|, |v213|
    v_max3_f32 v6, v6, |v214|, |v215|
    v_cvt_pk_bf16_f32 v80, v200, v201
    v_cvt_pk_bf16_f32 v81, v202, v203
    v_cvt_pk_bf16_f32 v82, v204, v205
    v_cvt_pk_bf16_f32 v83, v206, v207
    v_cvt_pk_bf16_f32 v84, v208, v209
    v_cvt_pk_bf16_f32 v85, v210, v211
    v_cvt_pk_bf16_f32 v86, v212, v213
    v_cvt_pk_bf16_f32 v87, v214, v215
    v_mul_f32_dpp v200, v24, v200 row_newbcast:15 row_mask:0xf bank_mask:0xf
    v_mul_f32_dpp v201, v25, v201 row_newbcast:15 row_mask:0xf bank_mask:0xf
    v_mul_f32_dpp v202, v26, v202 row_newbcast:15 row_mask:0xf bank_mask:0xf
    v_mul_f32_dpp v203, v27, v203 row_newbcast:15 row_mask:0xf bank_mask:0xf
    v_mul_f32_dpp v204, v28, v204 row_newbcast:15 row_mask:0xf bank_mask:0xf
    v_mul_f32_dpp v205, v29, v205 row_newbcast:15 row_mask:0xf bank_mask:0xf
    v_mul_f32_dpp v206, v30, v206 row_newbcast:15 row_mask:0xf bank_mask:0xf
    v_mul_f32_dpp v207, v31, v207 row_newbcast:15 row_mask:0xf bank_mask:0xf
    v_mul_f32_dpp v208, v24, v208 row_newbcast:15 row_mask:0xf bank_mask:0xf
    v_mul_f32_dpp v209, v25, v209 row_newbcast:15 row_mask:0xf bank_mask:0xf
    v_mul_f32_dpp v210, v26, v210 row_newbcast:15 row_mask:0xf bank_mask:0xf
    v_mul_f32_dpp v211, v27, v211 row_newbcast:15 row_mask:0xf bank_mask:0xf
    v_mul_f32_dpp v212, v28, v212 row_newbcast:15 row_mask:0xf bank_mask:0xf
    v_mul_f32_dpp v213, v29, v213 row_newbcast:15 row_mask:0xf bank_mask:0xf
    v_mul_f32_dpp v214, v30, v214 row_newbcast:15 row_mask:0xf bank_mask:0xf
    v_mul_f32_dpp v215, v31, v215 row_newbcast:15 row_mask:0xf bank_mask:0xf
    v_cvt_pk_bf16_f32 v216, v200, v201
    v_cvt_pk_bf16_f32 v217, v202, v203
    v_cvt_pk_bf16_f32 v218, v204, v205
    v_cvt_pk_bf16_f32 v219, v206, v207
    v_cvt_pk_bf16_f32 v220, v208, v209
    v_cvt_pk_bf16_f32 v221, v210, v211
    v_cvt_pk_bf16_f32 v222, v212, v213
    v_cvt_pk_bf16_f32 v223, v214, v215
    ds_write_b64 v8, v[216:217] offset:0
    ds_write_b64 v9, v[218:219] offset:0
    ds_write_b64 v9, v[220:221] offset:256
    ds_write_b64 v8, v[222:223] offset:256
    v_lshlrev_b32 v200, 16, v120
    v_and_b32 v201, 0xffff0000, v120
    v_lshlrev_b32 v202, 16, v121
    v_and_b32 v203, 0xffff0000, v121
    v_lshlrev_b32 v204, 16, v122
    v_and_b32 v205, 0xffff0000, v122
    v_lshlrev_b32 v206, 16, v123
    v_and_b32 v207, 0xffff0000, v123
    v_lshlrev_b32 v208, 16, v124
    v_and_b32 v209, 0xffff0000, v124
    v_lshlrev_b32 v210, 16, v125
    v_and_b32 v211, 0xffff0000, v125
    v_lshlrev_b32 v212, 16, v126
    v_and_b32 v213, 0xffff0000, v126
    v_lshlrev_b32 v214, 16, v127
    v_and_b32 v215, 0xffff0000, v127
    v_pk_mul_f32 v[200:201], v[200:201], s[12:13]
    v_pk_mul_f32 v[202:203], v[202:203], s[12:13]
    v_pk_mul_f32 v[204:205], v[204:205], s[12:13]
    v_pk_mul_f32 v[206:207], v[206:207], s[12:13]
    v_pk_mul_f32 v[208:209], v[208:209], s[12:13]
    v_pk_mul_f32 v[210:211], v[210:211], s[12:13]
    v_pk_mul_f32 v[212:213], v[212:213], s[12:13]
    v_pk_mul_f32 v[214:215], v[214:215], s[12:13]
    v_pk_mul_f32 v[200:201], v[200:201], v[160:161]
    v_pk_mul_f32 v[202:203], v[202:203], v[162:163]
    v_pk_mul_f32 v[204:205], v[204:205], v[164:165]
    v_pk_mul_f32 v[206:207], v[206:207], v[166:167]
    v_pk_mul_f32 v[208:209], v[208:209], v[168:169]
    v_pk_mul_f32 v[210:211], v[210:211], v[170:171]
    v_pk_mul_f32 v[212:213], v[212:213], v[172:173]
    v_pk_mul_f32 v[214:215], v[214:215], v[174:175]
    v_max3_f32 v6, v6, |v200|, |v201|
    v_max3_f32 v6, v6, |v202|, |v203|
    v_max3_f32 v6, v6, |v204|, |v205|
    v_max3_f32 v6, v6, |v206|, |v207|
    v_max3_f32 v6, v6, |v208|, |v209|
    v_max3_f32 v6, v6, |v210|, |v211|
    v_max3_f32 v6, v6, |v212|, |v213|
    v_max3_f32 v6, v6, |v214|, |v215|
    v_cvt_pk_bf16_f32 v88, v200, v201
    v_cvt_pk_bf16_f32 v89, v202, v203
    v_cvt_pk_bf16_f32 v90, v204, v205
    v_cvt_pk_bf16_f32 v91, v206, v207
    v_cvt_pk_bf16_f32 v92, v208, v209
    v_cvt_pk_bf16_f32 v93, v210, v211
    v_cvt_pk_bf16_f32 v94, v212, v213
    v_cvt_pk_bf16_f32 v95, v214, v215
    v_mul_f32_dpp v200, v40, v200 row_newbcast:15 row_mask:0xf bank_mask:0xf
    v_mul_f32_dpp v201, v41, v201 row_newbcast:15 row_mask:0xf bank_mask:0xf
    v_mul_f32_dpp v202, v42, v202 row_newbcast:15 row_mask:0xf bank_mask:0xf
    v_mul_f32_dpp v203, v43, v203 row_newbcast:15 row_mask:0xf bank_mask:0xf
    v_mul_f32_dpp v204, v44, v204 row_newbcast:15 row_mask:0xf bank_mask:0xf
    v_mul_f32_dpp v205, v45, v205 row_newbcast:15 row_mask:0xf bank_mask:0xf
    v_mul_f32_dpp v206, v46, v206 row_newbcast:15 row_mask:0xf bank_mask:0xf
    v_mul_f32_dpp v207, v47, v207 row_newbcast:15 row_mask:0xf bank_mask:0xf
    v_mul_f32_dpp v208, v40, v208 row_newbcast:15 row_mask:0xf bank_mask:0xf
    v_mul_f32_dpp v209, v41, v209 row_newbcast:15 row_mask:0xf bank_mask:0xf
    v_mul_f32_dpp v210, v42, v210 row_newbcast:15 row_mask:0xf bank_mask:0xf
    v_mul_f32_dpp v211, v43, v211 row_newbcast:15 row_mask:0xf bank_mask:0xf
    v_mul_f32_dpp v212, v44, v212 row_newbcast:15 row_mask:0xf bank_mask:0xf
    v_mul_f32_dpp v213, v45, v213 row_newbcast:15 row_mask:0xf bank_mask:0xf
    v_mul_f32_dpp v214, v46, v214 row_newbcast:15 row_mask:0xf bank_mask:0xf
    v_mul_f32_dpp v215, v47, v215 row_newbcast:15 row_mask:0xf bank_mask:0xf
    v_cvt_pk_bf16_f32 v216, v200, v201
    v_cvt_pk_bf16_f32 v217, v202, v203
    v_cvt_pk_bf16_f32 v218, v204, v205
    v_cvt_pk_bf16_f32 v219, v206, v207
    v_cvt_pk_bf16_f32 v220, v208, v209
    v_cvt_pk_bf16_f32 v221, v210, v211
    v_cvt_pk_bf16_f32 v222, v212, v213
    v_cvt_pk_bf16_f32 v223, v214, v215
    ds_write_b64 v10, v[216:217] offset:0
    ds_write_b64 v11, v[218:219] offset:0
    ds_write_b64 v11, v[220:221] offset:256
    ds_write_b64 v10, v[222:223] offset:256
    ds_read_b64_tr_b16 v[224:225], v240 offset:0
    ds_read_b64_tr_b16 v[226:227], v241 offset:512
    ds_read_b64_tr_b16 v[228:229], v241 offset:0
    ds_read_b64_tr_b16 v[230:231], v240 offset:512
    ds_read_b64_tr_b16 v[232:233], v242 offset:0
    ds_read_b64_tr_b16 v[234:235], v243 offset:512
    ds_read_b64_tr_b16 v[236:237], v243 offset:0
    s_waitcnt lgkmcnt(14)
    ds_read_b64_tr_b16 v[238:239], v242 offset:512
    s_waitcnt lgkmcnt(0)
    ds_write_b128 v244, v[224:227] offset:0
    ds_write_b128 v244, v[228:231] offset:1024
    ds_write_b128 v244, v[232:235] offset:2048
    ds_write_b128 v244, v[236:239] offset:3072
    s_waitcnt vmcnt(4)
    s_add_u32 m0, s60, 4992
    s_nop 0
    buffer_load_dwordx4 v2, s[36:39], s6 offen offset:128 nt lds
    s_waitcnt vmcnt(4)
    s_add_u32 m0, s60, 5760
    s_nop 0
    buffer_load_dwordx4 v1, s[36:39], s6 offen offset:384 nt lds
    s_waitcnt vmcnt(4)
    s_add_u32 m0, s60, 6784
    s_nop 0
    buffer_load_dwordx4 v2, s[36:39], s6 offen offset:384 nt lds
    s_waitcnt vmcnt(4)
    v_mov_b32 v254, s14
    v_mov_b32 v255, 0
    s_lshl_b32 s82, s3, 2
    s_mov_b64 exec, 1
    s_cmp_lg_u32 s5, 0
    s_cbranch_scc1 L_noatom
    buffer_atomic_cmpswap v[254:255], off, s[52:55], s82 offset:0 sc0 sc1
    buffer_load_dword v253, off, s[52:55], s82 offset:128 sc1
    s_branch L_atomdone
L_noatom:
    buffer_load_dword v253, off, s[36:39], s6
    buffer_load_dword v254, off, s[36:39], s6
L_atomdone:
    s_mov_b64 exec, -1
    s_add_u32 m0, s61, 0
    s_nop 0
    buffer_load_dwordx4 v3, s[40:43], s62 offen nt lds
    s_add_u32 s62, s62, 8192
    ds_read_b128 v[112:115], v12 offset:4096
    ds_read_b128 v[116:119], v12 offset:6144
    ds_read_b128 v[120:123], v13 offset:4096
    ds_read_b128 v[124:127], v13 offset:6144
    s_waitcnt lgkmcnt(3)
    v_lshlrev_b32 v144, 16, v112
    v_and_b32 v145, 0xffff0000, v112
    v_lshlrev_b32 v146, 16, v113
    v_and_b32 v147, 0xffff0000, v113
    v_lshlrev_b32 v148, 16, v114
    v_and_b32 v149, 0xffff0000, v114
    v_lshlrev_b32 v150, 16, v115
    v_and_b32 v151, 0xffff0000, v115
    s_waitcnt lgkmcnt(2)
    v_lshlrev_b32 v192, 16, v116
    v_and_b32 v193, 0xffff0000, v116
    v_lshlrev_b32 v194, 16, v117
    v_and_b32 v195, 0xffff0000, v117
    v_lshlrev_b32 v196, 16, v118
    v_and_b32 v197, 0xffff0000, v118
    v_lshlrev_b32 v198, 16, v119
    v_and_b32 v199, 0xffff0000, v119
    v_pk_mul_f32 v[144:145], v[144:145], s[8:9]
    v_pk_mul_f32 v[146:147], v[146:147], s[8:9]
    v_pk_mul_f32 v[148:149], v[148:149], s[8:9]
    v_pk_mul_f32 v[150:151], v[150:151], s[8:9]
    v_pk_mul_f32 v[192:193], v[192:193], s[8:9]
    v_pk_mul_f32 v[194:195], v[194:195], s[8:9]
    v_pk_mul_f32 v[196:197], v[196:197], s[8:9]
    v_pk_mul_f32 v[198:199], v[198:199], s[8:9]
    v_exp_f32 v144, v144
    v_exp_f32 v192, v192
    v_exp_f32 v145, v145
    v_exp_f32 v193, v193
    v_exp_f32 v146, v146
    v_exp_f32 v194, v194
    v_exp_f32 v147, v147
    v_exp_f32 v195, v195
    v_exp_f32 v148, v148
    v_exp_f32 v196, v196
    v_exp_f32 v149, v149
    v_exp_f32 v197, v197
    v_exp_f32 v150, v150
    v_exp_f32 v198, v198
    v_exp_f32 v151, v151
    v_exp_f32 v199, v199
    v_pk_add_f32 v[144:145], v[144:145], s[10:11]
    v_pk_add_f32 v[146:147], v[146:147], s[10:11]
    v_pk_add_f32 v[148:149], v[148:149], s[10:11]
    v_pk_add_f32 v[150:151], v[150:151], s[10:11]
    v_pk_add_f32 v[192:193], v[192:193], s[10:11]
    v_pk_add_f32 v[194:195], v[194:195], s[10:11]
    v_pk_add_f32 v[196:197], v[196:197], s[10:11]
    v_pk_add_f32 v[198:199], v[198:199], s[10:11]
    v_pk_mul_f32 v[152:153], v[144:145], v[192:193]
    v_pk_mul_f32 v[154:155], v[146:147], v[194:195]
    v_pk_mul_f32 v[156:157], v[148:149], v[196:197]
    v_pk_mul_f32 v[158:159], v[150:151], v[198:199]
    v_mul_f32_dpp v152, v152, v152 row_shr:1 row_mask:0xf bank_mask:0xf
    v_mul_f32_dpp v153, v153, v153 row_shr:1 row_mask:0xf bank_mask:0xf
    v_mul_f32_dpp v154, v154, v154 row_shr:1 row_mask:0xf bank_mask:0xf
    v_mul_f32_dpp v155, v155, v155 row_shr:1 row_mask:0xf bank_mask:0xf
    v_mul_f32_dpp v156, v156, v156 row_shr:1 row_mask:0xf bank_mask:0xf
    v_mul_f32_dpp v157, v157, v157 row_shr:1 row_mask:0xf bank_mask:0xf
    v_mul_f32_dpp v158, v158, v158 row_shr:1 row_mask:0xf bank_mask:0xf
    v_mul_f32_dpp v159, v159, v159 row_shr:1 row_mask:0xf bank_mask:0xf
    v_mul_f32_dpp v152, v152, v152 row_shr:2 row_mask:0xf bank_mask:0xf
    v_mul_f32_dpp v153, v153, v153 row_shr:2 row_mask:0xf bank_mask:0xf
    v_mul_f32_dpp v154, v154, v154 row_shr:2 row_mask:0xf bank_mask:0xf
    v_mul_f32_dpp v155, v155, v155 row_shr:2 row_mask:0xf bank_mask:0xf
    v_mul_f32_dpp v156, v156, v156 row_shr:2 row_mask:0xf bank_mask:0xf
    v_mul_f32_dpp v157, v157, v157 row_shr:2 row_mask:0xf bank_mask:0xf
    v_mul_f32_dpp v158, v158, v158 row_shr:2 row_mask:0xf bank_mask:0xf
    v_mul_f32_dpp v159, v159, v159 row_shr:2 row_mask:0xf bank_mask:0xf
    v_mul_f32_dpp v152, v152, v152 row_shr:4 row_mask:0xf bank_mask:0xf
    v_mul_f32_dpp v153, v153, v153 row_shr:4 row_mask:0xf bank_mask:0xf
    v_mul_f32_dpp v154, v154, v154 row_shr:4 row_mask:0xf bank_mask:0xf
    v_mul_f32_dpp v155, v155, v155 row_shr:4 row_mask:0xf bank_mask:0xf
    v_mul_f32_dpp v156, v156, v156 row_shr:4 row_mask:0xf bank_mask:0xf
    v_mul_f32_dpp v157, v157, v157 row_shr:4 row_mask:0xf bank_mask:0xf
    v_mul_f32_dpp v158, v158, v158 row_shr:4 row_mask:0xf bank_mask:0xf
    v_mul_f32_dpp v159, v159, v159 row_shr:4 row_mask:0xf bank_mask:0xf
    v_mul_f32_dpp v152, v152, v152 row_shr:8 row_mask:0xf bank_mask:0xf
    v_mul_f32_dpp v153, v153, v153 row_shr:8 row_mask:0xf bank_mask:0xf
    v_mul_f32_dpp v154, v154, v154 row_shr:8 row_mask:0xf bank_mask:0xf
    v_mul_f32_dpp v155, v155, v155 row_shr:8 row_mask:0xf bank_mask:0xf
    v_mul_f32_dpp v156, v156, v156 row_shr:8 row_mask:0xf bank_mask:0xf
    v_mul_f32_dpp v157, v157, v157 row_shr:8 row_mask:0xf bank_mask:0xf
    v_mul_f32_dpp v158, v158, v158 row_shr:8 row_mask:0xf bank_mask:0xf
    v_mul_f32_dpp v159, v159, v159 row_shr:8 row_mask:0xf bank_mask:0xf
    v_mul_f32_dpp v144, v152, v144 row_shr:1 row_mask:0xf bank_mask:0xf
    v_mul_f32_dpp v145, v153, v145 row_shr:1 row_mask:0xf bank_mask:0xf
    v_mul_f32_dpp v146, v154, v146 row_shr:1 row_mask:0xf bank_mask:0xf
    v_mul_f32_dpp v147, v155, v147 row_shr:1 row_mask:0xf bank_mask:0xf
    v_mul_f32_dpp v148, v156, v148 row_shr:1 row_mask:0xf bank_mask:0xf
    v_mul_f32_dpp v149, v157, v149 row_shr:1 row_mask:0xf bank_mask:0xf
    v_mul_f32_dpp v150, v158, v150 row_shr:1 row_mask:0xf bank_mask:0xf
    v_mul_f32_dpp v151, v159, v151 row_shr:1 row_mask:0xf bank_mask:0xf
    v_rcp_f32 v56, v152
    v_rcp_f32 v57, v153
    v_rcp_f32 v58, v154
    v_rcp_f32 v59, v155
    v_rcp_f32 v60, v156
    v_rcp_f32 v61, v157
    v_rcp_f32 v62, v158
    v_rcp_f32 v63, v159
    v_max3_f32 v6, v6, v152, v153
    v_max3_f32 v6, v6, v154, v155
    v_max3_f32 v6, v6, v156, v157
    v_max3_f32 v6, v6, v158, v159
    v_pk_mul_f32 v[48:49], v[56:57], v[192:193]
    v_pk_mul_f32 v[50:51], v[58:59], v[194:195]
    v_pk_mul_f32 v[52:53], v[60:61], v[196:197]
    v_pk_mul_f32 v[54:55], v[62:63], v[198:199]
    s_mov_b32 exec_lo, 0x80008000
    s_mov_b32 exec_hi, 0x80008000
    ds_write_b128 v5, v[56:59] offset:64
    ds_write_b128 v5, v[60:63] offset:80
    s_mov_b64 exec, -1
    s_waitcnt lgkmcnt(3)
    v_lshlrev_b32 v160, 16, v120
    v_and_b32 v161, 0xffff0000, v120
    v_lshlrev_b32 v162, 16, v121
    v_and_b32 v163, 0xffff0000, v121
    v_lshlrev_b32 v164, 16, v122
    v_and_b32 v165, 0xffff0000, v122
    v_lshlrev_b32 v166, 16, v123
    v_and_b32 v167, 0xffff0000, v123
    s_waitcnt lgkmcnt(2)
    v_lshlrev_b32 v192, 16, v124
    v_and_b32 v193, 0xffff0000, v124
    v_lshlrev_b32 v194, 16, v125
    v_and_b32 v195, 0xffff0000, v125
    v_lshlrev_b32 v196, 16, v126
    v_and_b32 v197, 0xffff0000, v126
    v_lshlrev_b32 v198, 16, v127
    v_and_b32 v199, 0xffff0000, v127
    v_pk_mul_f32 v[160:161], v[160:161], s[8:9]
    v_pk_mul_f32 v[162:163], v[162:163], s[8:9]
    v_pk_mul_f32 v[164:165], v[164:165], s[8:9]
    v_pk_mul_f32 v[166:167], v[166:167], s[8:9]
    v_pk_mul_f32 v[192:193], v[192:193], s[8:9]
    v_pk_mul_f32 v[194:195], v[194:195], s[8:9]
    v_pk_mul_f32 v[196:197], v[196:197], s[8:9]
    v_pk_mul_f32 v[198:199], v[198:199], s[8:9]
    v_exp_f32 v160, v160
    v_exp_f32 v192, v192
    v_exp_f32 v161, v161
    v_exp_f32 v193, v193
    v_exp_f32 v162, v162
    v_exp_f32 v194, v194
    v_exp_f32 v163, v163
    v_exp_f32 v195, v195
    v_exp_f32 v164, v164
    v_exp_f32 v196, v196
    v_exp_f32 v165, v165
    v_exp_f32 v197, v197
    v_exp_f32 v166, v166
    v_exp_f32 v198, v198
    v_exp_f32 v167, v167
    v_exp_f32 v199, v199
    v_pk_add_f32 v[160:161], v[160:161], s[10:11]
    v_pk_add_f32 v[162:163], v[162:163], s[10:11]
    v_pk_add_f32 v[164:165], v[164:165], s[10:11]
    v_pk_add_f32 v[166:167], v[166:167], s[10:11]
    v_pk_add_f32 v[192:193], v[192:193], s[10:11]
    v_pk_add_f32 v[194:195], v[194:195], s[10:11]
    v_pk_add_f32 v[196:197], v[196:197], s[10:11]
    v_pk_add_f32 v[198:199], v[198:199], s[10:11]
    v_pk_mul_f32 v[168:169], v[160:161], v[192:193]
    v_pk_mul_f32 v[170:171], v[162:163], v[194:195]
    v_pk_mul_f32 v[172:173], v[164:165], v[196:197]
    v_pk_mul_f32 v[174:175], v[166:167], v[198:199]
    v_mul_f32_dpp v168, v168, v168 row_shr:1 row_mask:0xf bank_mask:0xf
    v_mul_f32_dpp v169, v169, v169 row_shr:1 row_mask:0xf bank_mask:0xf
    v_mul_f32_dpp v170, v170, v170 row_shr:1 row_mask:0xf bank_mask:0xf
    v_mul_f32_dpp v171, v171, v171 row_shr:1 row_mask:0xf bank_mask:0xf
    v_mul_f32_dpp v172, v172, v172 row_shr:1 row_mask:0xf bank_mask:0xf
    v_mul_f32_dpp v173, v173, v173 row_shr:1 row_mask:0xf bank_mask:0xf
    v_mul_f32_dpp v174, v174, v174 row_shr:1 row_mask:0xf bank_mask:0xf
    v_mul_f32_dpp v175, v175, v175 row_shr:1 row_mask:0xf bank_mask:0xf
    v_mul_f32_dpp v168, v168, v168 row_shr:2 row_mask:0xf bank_mask:0xf
    v_mul_f32_dpp v169, v169, v169 row_shr:2 row_mask:0xf bank_mask:0xf
    v_mul_f32_dpp v170, v170, v170 row_shr:2 row_mask:0xf bank_mask:0xf
    v_mul_f32_dpp v171, v171, v171 row_shr:2 row_mask:0xf bank_mask:0xf
    v_mul_f32_dpp v172, v172, v172 row_shr:2 row_mask:0xf bank_mask:0xf
    v_mul_f32_dpp v173, v173, v173 row_shr:2 row_mask:0xf bank_mask:0xf
    v_mul_f32_dpp v174, v174, v174 row_shr:2 row_mask:0xf bank_mask:0xf
    v_mul_f32_dpp v175, v175, v175 row_shr:2 row_mask:0xf bank_mask:0xf
    v_mul_f32_dpp v168, v168, v168 row_shr:4 row_mask:0xf bank_mask:0xf
    v_mul_f32_dpp v169, v169, v169 row_shr:4 row_mask:0xf bank_mask:0xf
    v_mul_f32_dpp v170, v170, v170 row_shr:4 row_mask:0xf bank_mask:0xf
    v_mul_f32_dpp v171, v171, v171 row_shr:4 row_mask:0xf bank_mask:0xf
    v_mul_f32_dpp v172, v172, v172 row_shr:4 row_mask:0xf bank_mask:0xf
    v_mul_f32_dpp v173, v173, v173 row_shr:4 row_mask:0xf bank_mask:0xf
    v_mul_f32_dpp v174, v174, v174 row_shr:4 row_mask:0xf bank_mask:0xf
    v_mul_f32_dpp v175, v175, v175 row_shr:4 row_mask:0xf bank_mask:0xf
    v_mul_f32_dpp v168, v168, v168 row_shr:8 row_mask:0xf bank_mask:0xf
    v_mul_f32_dpp v169, v169, v169 row_shr:8 row_mask:0xf bank_mask:0xf
    v_mul_f32_dpp v170, v170, v170 row_shr:8 row_mask:0xf bank_mask:0xf
    v_mul_f32_dpp v171, v171, v171 row_shr:8 row_mask:0xf bank_mask:0xf
    v_mul_f32_dpp v172, v172, v172 row_shr:8 row_mask:0xf bank_mask:0xf
    v_mul_f32_dpp v173, v173, v173 row_shr:8 row_mask:0xf bank_mask:0xf
    v_mul_f32_dpp v174, v174, v174 row_shr:8 row_mask:0xf bank_mask:0xf
    v_mul_f32_dpp v175, v175, v175 row_shr:8 row_mask:0xf bank_mask:0xf
    v_mul_f32_dpp v160, v168, v160 row_shr:1 row_mask:0xf bank_mask:0xf
    v_mul_f32_dpp v161, v169, v161 row_shr:1 row_mask:0xf bank_mask:0xf
    v_mul_f32_dpp v162, v170, v162 row_shr:1 row_mask:0xf bank_mask:0xf
    v_mul_f32_dpp v163, v171, v163 row_shr:1 row_mask:0xf bank_mask:0xf
    v_mul_f32_dpp v164, v172, v164 row_shr:1 row_mask:0xf bank_mask:0xf
    v_mul_f32_dpp v165, v173, v165 row_shr:1 row_mask:0xf bank_mask:0xf
    v_mul_f32_dpp v166, v174, v166 row_shr:1 row_mask:0xf bank_mask:0xf
    v_mul_f32_dpp v167, v175, v167 row_shr:1 row_mask:0xf bank_mask:0xf
    v_rcp_f32 v72, v168
    v_rcp_f32 v73, v169
    v_rcp_f32 v74, v170
    v_rcp_f32 v75, v171
    v_rcp_f32 v76, v172
    v_rcp_f32 v77, v173
    v_rcp_f32 v78, v174
    v_rcp_f32 v79, v175
    v_max3_f32 v6, v6, v168, v169
    v_max3_f32 v6, v6, v170, v171
    v_max3_f32 v6, v6, v172, v173
    v_max3_f32 v6, v6, v174, v175
    v_pk_mul_f32 v[64:65], v[72:73], v[192:193]
    v_pk_mul_f32 v[66:67], v[74:75], v[194:195]
    v_pk_mul_f32 v[68:69], v[76:77], v[196:197]
    v_pk_mul_f32 v[70:71], v[78:79], v[198:199]
    s_mov_b32 exec_lo, 0x80008000
    s_mov_b32 exec_hi, 0x80008000
    ds_write_b128 v5, v[72:75] offset:96
    ds_write_b128 v5, v[76:79] offset:112
    s_mov_b64 exec, -1
    s_waitcnt vmcnt(6)
    s_add_u32 m0, s61, 1024
    s_nop 0
    buffer_load_dwordx4 v3, s[40:43], s62 offen nt lds
    s_add_u32 s62, s62, 8192
    s_waitcnt vmcnt(6)
    s_add_u32 m0, s61, 2048
    s_nop 0
    buffer_load_dwordx4 v3, s[40:43], s62 offen nt lds
    s_add_u32 s62, s62, 8192
    s_waitcnt vmcnt(6)
    s_add_u32 m0, s61, 3072
    s_nop 0
    buffer_load_dwordx4 v3, s[40:43], s62 offen nt lds
    s_add_u32 s62, s62, 8192
    s_waitcnt vmcnt(6)
    s_add_u32 m0, s61, 4096
    s_nop 0
    buffer_load_dwordx4 v3, s[40:43], s62 offen nt lds
    s_add_u32 s62, s62, 4294909952
    ds_read_b128 v[112:115], v14 offset:4096
    ds_read_b128 v[116:119], v14 offset:6144
    ds_read_b128 v[120:123], v15 offset:4096
    ds_read_b128 v[124:127], v15 offset:6144
    s_waitcnt lgkmcnt(0)
    v_lshlrev_b32 v200, 16, v112
    v_and_b32 v201, 0xffff0000, v112
    v_lshlrev_b32 v202, 16, v113
    v_and_b32 v203, 0xffff0000, v113
    v_lshlrev_b32 v204, 16, v114
    v_and_b32 v205, 0xffff0000, v114
    v_lshlrev_b32 v206, 16, v115
    v_and_b32 v207, 0xffff0000, v115
    v_lshlrev_b32 v208, 16, v116
    v_and_b32 v209, 0xffff0000, v116
    v_lshlrev_b32 v210, 16, v117
    v_and_b32 v211, 0xffff0000, v117
    v_lshlrev_b32 v212, 16, v118
    v_and_b32 v213, 0xffff0000, v118
    v_lshlrev_b32 v214, 16, v119
    v_and_b32 v215, 0xffff0000, v119
    v_pk_mul_f32 v[200:201], v[200:201], s[12:13]
    v_pk_mul_f32 v[202:203], v[202:203], s[12:13]
    v_pk_mul_f32 v[204:205], v[204:205], s[12:13]
    v_pk_mul_f32 v[206:207], v[206:207], s[12:13]
    v_pk_mul_f32 v[208:209], v[208:209], s[12:13]
    v_pk_mul_f32 v[210:211], v[210:211], s[12:13]
    v_pk_mul_f32 v[212:213], v[212:213], s[12:13]
    v_pk_mul_f32 v[214:215], v[214:215], s[12:13]
    v_pk_mul_f32 v[200:201], v[200:201], v[144:145]
    v_pk_mul_f32 v[202:203], v[202:203], v[146:147]
    v_pk_mul_f32 v[204:205], v[204:205], v[148:149]
    v_pk_mul_f32 v[206:207], v[206:207], v[150:151]
    v_pk_mul_f32 v[208:209], v[208:209], v[152:153]
    v_pk_mul_f32 v[210:211], v[210:211], v[154:155]
    v_pk_mul_f32 v[212:213], v[212:213], v[156:157]
    v_pk_mul_f32 v[214:215], v[214:215], v[158:159]
    v_max3_f32 v6, v6, |v200|, |v201|
    v_max3_f32 v6, v6, |v202|, |v203|
    v_max3_f32 v6, v6, |v204|, |v205|
    v_max3_f32 v6, v6, |v206|, |v207|
    v_max3_f32 v6, v6, |v208|, |v209|
    v_max3_f32 v6, v6, |v210|, |v211|
    v_max3_f32 v6, v6, |v212|, |v213|
    v_max3_f32 v6, v6, |v214|, |v215|
    v_cvt_pk_bf16_f32 v96, v200, v201
    v_cvt_pk_bf16_f32 v97, v202, v203
    v_cvt_pk_bf16_f32 v98, v204, v205
    v_cvt_pk_bf16_f32 v99, v206, v207
    v_cvt_pk_bf16_f32 v100, v208, v209
    v_cvt_pk_bf16_f32 v101, v210, v211
    v_cvt_pk_bf16_f32 v102, v212, v213
    v_cvt_pk_bf16_f32 v103, v214, v215
    v_mul_f32_dpp v200, v56, v200 row_newbcast:15 row_mask:0xf bank_mask:0xf
    v_mul_f32_dpp v201, v57, v201 row_newbcast:15 row_mask:0xf bank_mask:0xf
    v_mul_f32_dpp v202, v58, v202 row_newbcast:15 row_mask:0xf bank_mask:0xf
    v_mul_f32_dpp v203, v59, v203 row_newbcast:15 row_mask:0xf bank_mask:0xf
    v_mul_f32_dpp v204, v60, v204 row_newbcast:15 row_mask:0xf bank_mask:0xf
    v_mul_f32_dpp v205, v61, v205 row_newbcast:15 row_mask:0xf bank_mask:0xf
    v_mul_f32_dpp v206, v62, v206 row_newbcast:15 row_mask:0xf bank_mask:0xf
    v_mul_f32_dpp v207, v63, v207 row_newbcast:15 row_mask:0xf bank_mask:0xf
    v_mul_f32_dpp v208, v56, v208 row_newbcast:15 row_mask:0xf bank_mask:0xf
    v_mul_f32_dpp v209, v57, v209 row_newbcast:15 row_mask:0xf bank_mask:0xf
    v_mul_f32_dpp v210, v58, v210 row_newbcast:15 row_mask:0xf bank_mask:0xf
    v_mul_f32_dpp v211, v59, v211 row_newbcast:15 row_mask:0xf bank_mask:0xf
    v_mul_f32_dpp v212, v60, v212 row_newbcast:15 row_mask:0xf bank_mask:0xf
    v_mul_f32_dpp v213, v61, v213 row_newbcast:15 row_mask:0xf bank_mask:0xf
    v_mul_f32_dpp v214, v62, v214 row_newbcast:15 row_mask:0xf bank_mask:0xf
    v_mul_f32_dpp v215, v63, v215 row_newbcast:15 row_mask:0xf bank_mask:0xf
    v_cvt_pk_bf16_f32 v216, v200, v201
    v_cvt_pk_bf16_f32 v217, v202, v203
    v_cvt_pk_bf16_f32 v218, v204, v205
    v_cvt_pk_bf16_f32 v219, v206, v207
    v_cvt_pk_bf16_f32 v220, v208, v209
    v_cvt_pk_bf16_f32 v221, v210, v211
    v_cvt_pk_bf16_f32 v222, v212, v213
    v_cvt_pk_bf16_f32 v223, v214, v215
    ds_write_b64 v8, v[216:217] offset:4096
    ds_write_b64 v9, v[218:219] offset:4096
    ds_write_b64 v9, v[220:221] offset:4352
    ds_write_b64 v8, v[222:223] offset:4352
    v_lshlrev_b32 v200, 16, v120
    v_and_b32 v201, 0xffff0000, v120
    v_lshlrev_b32 v202, 16, v121
    v_and_b32 v203, 0xffff0000, v121
    v_lshlrev_b32 v204, 16, v122
    v_and_b32 v205, 0xffff0000, v122
    v_lshlrev_b32 v206, 16, v123
    v_and_b32 v207, 0xffff0000, v123
    v_lshlrev_b32 v208, 16, v124
    v_and_b32 v209, 0xffff0000, v124
    v_lshlrev_b32 v210, 16, v125
    v_and_b32 v211, 0xffff0000, v125
    v_lshlrev_b32 v212, 16, v126
    v_and_b32 v213, 0xffff0000, v126
    v_lshlrev_b32 v214, 16, v127
    v_and_b32 v215, 0xffff0000, v127
    v_pk_mul_f32 v[200:201], v[200:201], s[12:13]
    v_pk_mul_f32 v[202:203], v[202:203], s[12:13]
    v_pk_mul_f32 v[204:205], v[204:205], s[12:13]
    v_pk_mul_f32 v[206:207], v[206:207], s[12:13]
    v_pk_mul_f32 v[208:209], v[208:209], s[12:13]
    v_pk_mul_f32 v[210:211], v[210:211], s[12:13]
    v_pk_mul_f32 v[212:213], v[212:213], s[12:13]
    v_pk_mul_f32 v[214:215], v[214:215], s[12:13]
    v_pk_mul_f32 v[200:201], v[200:201], v[160:161]
    v_pk_mul_f32 v[202:203], v[202:203], v[162:163]
    v_pk_mul_f32 v[204:205], v[204:205], v[164:165]
    v_pk_mul_f32 v[206:207], v[206:207], v[166:167]
    v_pk_mul_f32 v[208:209], v[208:209], v[168:169]
    v_pk_mul_f32 v[210:211], v[210:211], v[170:171]
    v_pk_mul_f32 v[212:213], v[212:213], v[172:173]
    v_pk_mul_f32 v[214:215], v[214:215], v[174:175]
    v_max3_f32 v6, v6, |v200|, |v201|
    v_max3_f32 v6, v6, |v202|, |v203|
    v_max3_f32 v6, v6, |v204|, |v205|
    v_max3_f32 v6, v6, |v206|, |v207|
    v_max3_f32 v6, v6, |v208|, |v209|
    v_max3_f32 v6, v6, |v210|, |v211|
    v_max3_f32 v6, v6, |v212|, |v213|
    v_max3_f32 v6, v6, |v214|, |v215|
    v_cvt_pk_bf16_f32 v104, v200, v201
    v_cvt_pk_bf16_f32 v105, v202, v203
    v_cvt_pk_bf16_f32 v106, v204, v205
    v_cvt_pk_bf16_f32 v107, v206, v207
    v_cvt_pk_bf16_f32 v108, v208, v209
    v_cvt_pk_bf16_f32 v109, v210, v211
    v_cvt_pk_bf16_f32 v110, v212, v213
    v_cvt_pk_bf16_f32 v111, v214, v215
    v_mul_f32_dpp v200, v72, v200 row_newbcast:15 row_mask:0xf bank_mask:0xf
    v_mul_f32_dpp v201, v73, v201 row_newbcast:15 row_mask:0xf bank_mask:0xf
    v_mul_f32_dpp v202, v74, v202 row_newbcast:15 row_mask:0xf bank_mask:0xf
    v_mul_f32_dpp v203, v75, v203 row_newbcast:15 row_mask:0xf bank_mask:0xf
    v_mul_f32_dpp v204, v76, v204 row_newbcast:15 row_mask:0xf bank_mask:0xf
    v_mul_f32_dpp v205, v77, v205 row_newbcast:15 row_mask:0xf bank_mask:0xf
    v_mul_f32_dpp v206, v78, v206 row_newbcast:15 row_mask:0xf bank_mask:0xf
    v_mul_f32_dpp v207, v79, v207 row_newbcast:15 row_mask:0xf bank_mask:0xf
    v_mul_f32_dpp v208, v72, v208 row_newbcast:15 row_mask:0xf bank_mask:0xf
    v_mul_f32_dpp v209, v73, v209 row_newbcast:15 row_mask:0xf bank_mask:0xf
    v_mul_f32_dpp v210, v74, v210 row_newbcast:15 row_mask:0xf bank_mask:0xf
    v_mul_f32_dpp v211, v75, v211 row_newbcast:15 row_mask:0xf bank_mask:0xf
    v_mul_f32_dpp v212, v76, v212 row_newbcast:15 row_mask:0xf bank_mask:0xf
    v_mul_f32_dpp v213, v77, v213 row_newbcast:15 row_mask:0xf bank_mask:0xf
    v_mul_f32_dpp v214, v78, v214 row_newbcast:15 row_mask:0xf bank_mask:0xf
    v_mul_f32_dpp v215, v79, v215 row_newbcast:15 row_mask:0xf bank_mask:0xf
    v_cvt_pk_bf16_f32 v216, v200, v201
    v_cvt_pk_bf16_f32 v217, v202, v203
    v_cvt_pk_bf16_f32 v218, v204, v205
    v_cvt_pk_bf16_f32 v219, v206, v207
    v_cvt_pk_bf16_f32 v220, v208, v209
    v_cvt_pk_bf16_f32 v221, v210, v211
    v_cvt_pk_bf16_f32 v222, v212, v213
    v_cvt_pk_bf16_f32 v223, v214, v215
    ds_write_b64 v10, v[216:217] offset:4096
    ds_write_b64 v11, v[218:219] offset:4096
    ds_write_b64 v11, v[220:221] offset:4352
    ds_write_b64 v10, v[222:223] offset:4352
    ds_read_b64_tr_b16 v[224:225], v240 offset:4096
    ds_read_b64_tr_b16 v[226:227], v241 offset:4608
    ds_read_b64_tr_b16 v[228:229], v241 offset:4096
    ds_read_b64_tr_b16 v[230:231], v240 offset:4608
    ds_read_b64_tr_b16 v[232:233], v242 offset:4096
    ds_read_b64_tr_b16 v[234:235], v243 offset:4608
    ds_read_b64_tr_b16 v[236:237], v243 offset:4096
    s_waitcnt lgkmcnt(14)
    ds_read_b64_tr_b16 v[238:239], v242 offset:4608
    s_waitcnt lgkmcnt(0)
    ds_write_b128 v244, v[224:227] offset:4096
    ds_write_b128 v244, v[228:231] offset:5120
    ds_write_b128 v244, v[232:235] offset:6144
    ds_write_b128 v244, v[236:239] offset:7168
    v_mov_b32 v192, 0x5f800000
    v_cmp_nle_f32 s[30:31], v6, v192
    s_waitcnt vmcnt(5)
    v_readfirstlane_b32 s83, v253
    v_readfirstlane_b32 s82, v254
    s_nop 0
    s_cmp_eq_u32 s82, 0
    s_cselect_b32 s14, s14, s82
    s_cmp_lg_u32 s5, 0
    s_cbranch_scc1 L_noep
    v_mov_b32 v252, s14
    v_mov_b32 v255, 151552
    s_mov_b64 exec, 1
    ds_write_b64 v255, v[252:253]
    s_mov_b64 exec, -1
L_noep:
    v_mov_b32 v255, 151552
    s_cmp_lg_u64 s[30:31], 0
    s_cbranch_scc1 L_fbA
L_fbA_ret:
    v_lshrrev_b32 v5, 4, v0
    v_bfe_u32 v192, v0, 2, 2
    v_and_b32 v193, 1, v5
    v_and_b32 v194, 3, v0
    v_lshl_or_b32 v195, v193, 2, v192
    v_xor_b32 v195, s5, v195
    v_lshlrev_b32 v195, 5, v195
    v_lshl_add_u32 v195, v5, 14, v195
    v_lshl_add_u32 v195, v192, 8, v195
    v_lshl_add_u32 v195, v194, 3, v195
    v_add_u32 v4, 65536, v195
    v_lshrrev_b32 v5, 1, v7
    v_add_u32 v5, 147456, v5
    s_waitcnt vmcnt(4)
    s_add_u32 m0, s61, 5120
    s_nop 0
    buffer_load_dwordx4 v3, s[40:43], s62 offen nt lds
    s_add_u32 s62, s62, 8192
    s_waitcnt vmcnt(4)
    s_add_u32 m0, s61, 6144
    s_nop 0
    buffer_load_dwordx4 v3, s[40:43], s62 offen nt lds
    s_add_u32 s62, s62, 8192
    s_waitcnt vmcnt(4)
    s_add_u32 m0, s61, 7168
    s_nop 0
    buffer_load_dwordx4 v3, s[40:43], s62 offen nt lds
    s_waitcnt vmcnt(4) lgkmcnt(0)
    s_barrier
    ds_read_b64_tr_b16 v[124:125], v4 offset:0
    ds_read_b64_tr_b16 v[126:127], v4 offset:8192
    ds_read_b64_tr_b16 v[128:129], v4 offset:1024
    ds_read_b64_tr_b16 v[130:131], v4 offset:9216
    ds_read_b64_tr_b16 v[132:133], v4 offset:2048
    ds_read_b64_tr_b16 v[134:135], v4 offset:10240
    ds_read_b64_tr_b16 v[136:137], v4 offset:3072
    ds_read_b64_tr_b16 v[138:139], v4 offset:11264
    ds_read_b128 v[192:195], v7 offset:24576
    ds_read_b128 v[196:199], v7 offset:25600
    ds_read_b128 v[200:203], v7 offset:26624
    ds_read_b128 v[204:207], v7 offset:27648
    ds_read_b128 v[208:211], v7 offset:28672
    ds_read_b128 v[212:215], v7 offset:29696
    ds_read_b128 v[216:219], v7 offset:30720
    s_waitcnt lgkmcnt(14)
    ds_read_b128 v[220:223], v7 offset:31744
    s_waitcnt lgkmcnt(8)
    s_barrier
    s_add_u32 m0, s61, 0
    s_nop 0
    buffer_load_dwordx4 v1, s[32:35], s6 offen offset:0 nt lds
    s_add_u32 m0, s61, 1024
    s_nop 0
    buffer_load_dwordx4 v2, s[32:35], s6 offen offset:0 nt lds
    ds_read_b64 v[176:177], v5 offset:0
    ds_read_b64 v[178:179], v5 offset:512
    ds_read_b64 v[180:181], v5 offset:1024
    ds_read_b64 v[182:183], v5 offset:1536
    ds_read_b64 v[184:185], v5 offset:2048
    ds_read_b64 v[186:187], v5 offset:2560
    ds_read_b64 v[188:189], v5 offset:3072
    s_waitcnt lgkmcnt(14)
    ds_read_b64 v[190:191], v5 offset:3584
    s_waitcnt lgkmcnt(14)
    ds_read_b64 v[252:253], v255
    v_mfma_f32_16x16x32_bf16 v[144:147], v[192:195], v[124:127], 0
    s_waitcnt lgkmcnt(14)
    ds_read_b128 v[192:195], v7 offset:32768
    v_mfma_f32_16x16x32_bf16 v[148:151], v[196:199], v[124:127], 0
    s_waitcnt lgkmcnt(14)
    ds_read_b128 v[196:199], v7 offset:33792
    v_mfma_f32_16x16x32_bf16 v[152:155], v[200:203], v[124:127], 0
    s_waitcnt lgkmcnt(14)
    ds_read_b128 v[200:203], v7 offset:34816
    s_waitcnt lgkmcnt(7)
    v_mul_f32_dpp v144, v184, v144 row_newbcast:0 row_mask:0xf bank_mask:0xf
    v_mul_f32_dpp v145, v185, v145 row_newbcast:0 row_mask:0xf bank_mask:0xf
    v_mul_f32_dpp v146, v184, v146 row_newbcast:1 row_mask:0xf bank_mask:0xf
    v_mul_f32_dpp v147, v185, v147 row_newbcast:1 row_mask:0xf bank_mask:0xf
    v_mfma_f32_16x16x32_bf16 v[156:159], v[204:207], v[124:127], 0
    ds_read_b128 v[204:207], v7 offset:35840
    v_mul_f32_dpp v148, v184, v148 row_newbcast:2 row_mask:0xf bank_mask:0xf
    v_mul_f32_dpp v149, v185, v149 row_newbcast:2 row_mask:0xf bank_mask:0xf
    v_mul_f32_dpp v150, v184, v150 row_newbcast:3 row_mask:0xf bank_mask:0xf
    v_mul_f32_dpp v151, v185, v151 row_newbcast:3 row_mask:0xf bank_mask:0xf
    v_mfma_f32_16x16x32_bf16 v[160:163], v[208:211], v[124:127], 0
    ds_read_b128 v[208:211], v7 offset:36864
    v_mul_f32_dpp v152, v184, v152 row_newbcast:4 row_mask:0xf bank_mask:0xf
    v_mul_f32_dpp v153, v185, v153 row_newbcast:4 row_mask:0xf bank_mask:0xf
    v_mul_f32_dpp v154, v184, v154 row_newbcast:5 row_mask:0xf bank_mask:0xf
    v_mul_f32_dpp v155, v185, v155 row_newbcast:5 row_mask:0xf bank_mask:0xf
    v_mfma_f32_16x16x32_bf16 v[164:167], v[212:215], v[124:127], 0
    ds_read_b128 v[212:215], v7 offset:37888
    v_mul_f32_dpp v156, v184, v156 row_newbcast:6 row_mask:0xf bank_mask:0xf
    v_mul_f32_dpp v157, v185, v157 row_newbcast:6 row_mask:0xf bank_mask:0xf
    v_mul_f32_dpp v158, v184, v158 row_newbcast:7 row_mask:0xf bank_mask:0xf
    v_mul_f32_dpp v159, v185, v159 row_newbcast:7 row_mask:0xf bank_mask:0xf
    v_mfma_f32_16x16x32_bf16 v[168:171], v[216:219], v[124:127], 0
    ds_read_b128 v[216:219], v7 offset:38912
    v_mul_f32_dpp v160, v184, v160 row_newbcast:8 row_mask:0xf bank_mask:0xf
    v_mul_f32_dpp v161, v185, v161 row_newbcast:8 row_mask:0xf bank_mask:0xf
    v_mul_f32_dpp v162, v184, v162 row_newbcast:9 row_mask:0xf bank_mask:0xf
    v_mul_f32_dpp v163, v185, v163 row_newbcast:9 row_mask:0xf bank_mask:0xf
    v_mfma_f32_16x16x32_bf16 v[172:175], v[220:223], v[124:127], 0
    ds_read_b128 v[220:223], v7 offset:39936
    v_mul_f32_dpp v164, v184, v164 row_newbcast:10 row_mask:0xf bank_mask:0xf
    v_mul_f32_dpp v165, v185, v165 row_newbcast:10 row_mask:0xf bank_mask:0xf
    v_mul_f32_dpp v166, v184, v166 row_newbcast:11 row_mask:0xf bank_mask:0xf
    v_mul_f32_dpp v167, v185, v167 row_newbcast:11 row_mask:0xf bank_mask:0xf
    v_mul_f32_dpp v168, v184, v168 row_newbcast:12 row_mask:0xf bank_mask:0xf
    v_mul_f32_dpp v169, v185, v169 row_newbcast:12 row_mask:0xf bank_mask:0xf
    v_mul_f32_dpp v170, v184, v170 row_newbcast:13 row_mask:0xf bank_mask:0xf
    v_mul_f32_dpp v171, v185, v171 row_newbcast:13 row_mask:0xf bank_mask:0xf
    v_mul_f32_dpp v172, v184, v172 row_newbcast:14 row_mask:0xf bank_mask:0xf
    v_mul_f32_dpp v173, v185, v173 row_newbcast:14 row_mask:0xf bank_mask:0xf
    v_mul_f32_dpp v174, v184, v174 row_newbcast:15 row_mask:0xf bank_mask:0xf
    v_mul_f32_dpp v175, v185, v175 row_newbcast:15 row_mask:0xf bank_mask:0xf
    s_waitcnt lgkmcnt(7)
    v_mfma_f32_16x16x32_bf16 v[144:147], v[192:195], v[128:131], v[144:147]
    ds_read_b128 v[192:195], v7 offset:40960
    s_waitcnt lgkmcnt(7)
    v_mfma_f32_16x16x32_bf16 v[148:151], v[196:199], v[128:131], v[148:151]
    ds_read_b128 v[196:199], v7 offset:41984
    s_waitcnt lgkmcnt(7)
    v_mfma_f32_16x16x32_bf16 v[152:155], v[200:203], v[128:131], v[152:155]
    ds_read_b128 v[200:203], v7 offset:43008
    s_nop 0
    v_mul_f32_dpp v144, v186, v144 row_newbcast:0 row_mask:0xf bank_mask:0xf
    v_mul_f32_dpp v145, v187, v145 row_newbcast:0 row_mask:0xf bank_mask:0xf
    v_mul_f32_dpp v146, v186, v146 row_newbcast:1 row_mask:0xf bank_mask:0xf
    v_mul_f32_dpp v147, v187, v147 row_newbcast:1 row_mask:0xf bank_mask:0xf
    s_waitcnt lgkmcnt(7)
    v_mfma_f32_16x16x32_bf16 v[156:159], v[204:207], v[128:131], v[156:159]
    ds_read_b128 v[204:207], v7 offset:44032
    v_mul_f32_dpp v148, v186, v148 row_newbcast:2 row_mask:0xf bank_mask:0xf
    v_mul_f32_dpp v149, v187, v149 row_newbcast:2 row_mask:0xf bank_mask:0xf
    v_mul_f32_dpp v150, v186, v150 row_newbcast:3 row_mask:0xf bank_mask:0xf
    v_mul_f32_dpp v151, v187, v151 row_newbcast:3 row_mask:0xf bank_mask:0xf
    s_waitcnt lgkmcnt(7)
    v_mfma_f32_16x16x32_bf16 v[160:163], v[208:211], v[128:131], v[160:163]
    ds_read_b128 v[208:211], v7 offset:45056
    v_mul_f32_dpp v152, v186, v152 row_newbcast:4 row_mask:0xf bank_mask:0xf
    v_mul_f32_dpp v153, v187, v153 row_newbcast:4 row_mask:0xf bank_mask:0xf
    v_mul_f32_dpp v154, v186, v154 row_newbcast:5 row_mask:0xf bank_mask:0xf
    v_mul_f32_dpp v155, v187, v155 row_newbcast:5 row_mask:0xf bank_mask:0xf
    s_waitcnt lgkmcnt(7)
    v_mfma_f32_16x16x32_bf16 v[164:167], v[212:215], v[128:131], v[164:167]
    ds_read_b128 v[212:215], v7 offset:46080
    v_mul_f32_dpp v156, v186, v156 row_newbcast:6 row_mask:0xf bank_mask:0xf
    v_mul_f32_dpp v157, v187, v157 row_newbcast:6 row_mask:0xf bank_mask:0xf
    v_mul_f32_dpp v158, v186, v158 row_newbcast:7 row_mask:0xf bank_mask:0xf
    v_mul_f32_dpp v159, v187, v159 row_newbcast:7 row_mask:0xf bank_mask:0xf
    s_waitcnt lgkmcnt(7)
    v_mfma_f32_16x16x32_bf16 v[168:171], v[216:219], v[128:131], v[168:171]
    ds_read_b128 v[216:219], v7 offset:47104
    v_mul_f32_dpp v160, v186, v160 row_newbcast:8 row_mask:0xf bank_mask:0xf
    v_mul_f32_dpp v161, v187, v161 row_newbcast:8 row_mask:0xf bank_mask:0xf
    v_mul_f32_dpp v162, v186, v162 row_newbcast:9 row_mask:0xf bank_mask:0xf
    v_mul_f32_dpp v163, v187, v163 row_newbcast:9 row_mask:0xf bank_mask:0xf
    s_waitcnt lgkmcnt(7)
    v_mfma_f32_16x16x32_bf16 v[172:175], v[220:223], v[128:131], v[172:175]
    ds_read_b128 v[220:223], v7 offset:48128
    v_mul_f32_dpp v164, v186, v164 row_newbcast:10 row_mask:0xf bank_mask:0xf
    v_mul_f32_dpp v165, v187, v165 row_newbcast:10 row_mask:0xf bank_mask:0xf
    v_mul_f32_dpp v166, v186, v166 row_newbcast:11 row_mask:0xf bank_mask:0xf
    v_mul_f32_dpp v167, v187, v167 row_newbcast:11 row_mask:0xf bank_mask:0xf
    v_mul_f32_dpp v168, v186, v168 row_newbcast:12 row_mask:0xf bank_mask:0xf
    v_mul_f32_dpp v169, v187, v169 row_newbcast:12 row_mask:0xf bank_mask:0xf
    v_mul_f32_dpp v170, v186, v170 row_newbcast:13 row_mask:0xf bank_mask:0xf
    v_mul_f32_dpp v171, v187, v171 row_newbcast:13 row_mask:0xf bank_mask:0xf
    v_mul_f32_dpp v172, v186, v172 row_newbcast:14 row_mask:0xf bank_mask:0xf
    v_mul_f32_dpp v173, v187, v173 row_newbcast:14 row_mask:0xf bank_mask:0xf
    v_mul_f32_dpp v174, v186, v174 row_newbcast:15 row_mask:0xf bank_mask:0xf
    v_mul_f32_dpp v175, v187, v175 row_newbcast:15 row_mask:0xf bank_mask:0xf
    s_waitcnt lgkmcnt(7)
    v_mfma_f32_16x16x32_bf16 v[144:147], v[192:195], v[132:135], v[144:147]
    ds_read_b128 v[192:195], v7 offset:49152
    s_waitcnt lgkmcnt(7)
    v_mfma_f32_16x16x32_bf16 v[148:151], v[196:199], v[132:135], v[148:151]
    ds_read_b128 v[196:199], v7 offset:50176
    s_waitcnt lgkmcnt(7)
    v_mfma_f32_16x16x32_bf16 v[152:155], v[200:203], v[132:135], v[152:155]
    ds_read_b128 v[200:203], v7 offset:51200
    s_nop 0
    v_mul_f32_dpp v144, v188, v144 row_newbcast:0 row_mask:0xf bank_mask:0xf
    v_mul_f32_dpp v145, v189, v145 row_newbcast:0 row_mask:0xf bank_mask:0xf
    v_mul_f32_dpp v146, v188, v146 row_newbcast:1 row_mask:0xf bank_mask:0xf
    v_mul_f32_dpp v147, v189, v147 row_newbcast:1 row_mask:0xf bank_mask:0xf
    s_waitcnt lgkmcnt(7)
    v_mfma_f32_16x16x32_bf16 v[156:159], v[204:207], v[132:135], v[156:159]
    ds_read_b128 v[204:207], v7 offset:52224
    v_mul_f32_dpp v148, v188, v148 row_newbcast:2 row_mask:0xf bank_mask:0xf
    v_mul_f32_dpp v149, v189, v149 row_newbcast:2 row_mask:0xf bank_mask:0xf
    v_mul_f32_dpp v150, v188, v150 row_newbcast:3 row_mask:0xf bank_mask:0xf
    v_mul_f32_dpp v151, v189, v151 row_newbcast:3 row_mask:0xf bank_mask:0xf
    s_waitcnt lgkmcnt(7)
    v_mfma_f32_16x16x32_bf16 v[160:163], v[208:211], v[132:135], v[160:163]
    ds_read_b128 v[208:211], v7 offset:53248
    v_mul_f32_dpp v152, v188, v152 row_newbcast:4 row_mask:0xf bank_mask:0xf
    v_mul_f32_dpp v153, v189, v153 row_newbcast:4 row_mask:0xf bank_mask:0xf
    v_mul_f32_dpp v154, v188, v154 row_newbcast:5 row_mask:0xf bank_mask:0xf
    v_mul_f32_dpp v155, v189, v155 row_newbcast:5 row_mask:0xf bank_mask:0xf
    s_waitcnt lgkmcnt(7)
    v_mfma_f32_16x16x32_bf16 v[164:167], v[212:215], v[132:135], v[164:167]
    ds_read_b128 v[212:215], v7 offset:54272
    v_mul_f32_dpp v156, v188, v156 row_newbcast:6 row_mask:0xf bank_mask:0xf
    v_mul_f32_dpp v157, v189, v157 row_newbcast:6 row_mask:0xf bank_mask:0xf
    v_mul_f32_dpp v158, v188, v158 row_newbcast:7 row_mask:0xf bank_mask:0xf
    v_mul_f32_dpp v159, v189, v159 row_newbcast:7 row_mask:0xf bank_mask:0xf
    s_waitcnt lgkmcnt(7)
    v_mfma_f32_16x16x32_bf16 v[168:171], v[216:219], v[132:135], v[168:171]
    ds_read_b128 v[216:219], v7 offset:55296
    v_mul_f32_dpp v160, v188, v160 row_newbcast:8 row_mask:0xf bank_mask:0xf
    v_mul_f32_dpp v161, v189, v161 row_newbcast:8 row_mask:0xf bank_mask:0xf
    v_mul_f32_dpp v162, v188, v162 row_newbcast:9 row_mask:0xf bank_mask:0xf
    v_mul_f32_dpp v163, v189, v163 row_newbcast:9 row_mask:0xf bank_mask:0xf
    s_waitcnt lgkmcnt(7)
    v_mfma_f32_16x16x32_bf16 v[172:175], v[220:223], v[132:135], v[172:175]
    ds_read_b128 v[220:223], v7 offset:56320
    v_mul_f32_dpp v164, v188, v164 row_newbcast:10 row_mask:0xf bank_mask:0xf
    v_mul_f32_dpp v165, v189, v165 row_newbcast:10 row_mask:0xf bank_mask:0xf
    v_mul_f32_dpp v166, v188, v166 row_newbcast:11 row_mask:0xf bank_mask:0xf
    v_mul_f32_dpp v167, v189, v167 row_newbcast:11 row_mask:0xf bank_mask:0xf
    v_mul_f32_dpp v168, v188, v168 row_newbcast:12 row_mask:0xf bank_mask:0xf
    v_mul_f32_dpp v169, v189, v169 row_newbcast:12 row_mask:0xf bank_mask:0xf
    v_mul_f32_dpp v170, v188, v170 row_newbcast:13 row_mask:0xf bank_mask:0xf
    v_mul_f32_dpp v171, v189, v171 row_newbcast:13 row_mask:0xf bank_mask:0xf
    v_mul_f32_dpp v172, v188, v172 row_newbcast:14 row_mask:0xf bank_mask:0xf
    v_mul_f32_dpp v173, v189, v173 row_newbcast:14 row_mask:0xf bank_mask:0xf
    v_mul_f32_dpp v174, v188, v174 row_newbcast:15 row_mask:0xf bank_mask:0xf
    v_mul_f32_dpp v175, v189, v175 row_newbcast:15 row_mask:0xf bank_mask:0xf
    s_waitcnt lgkmcnt(7)
    v_mfma_f32_16x16x32_bf16 v[144:147], v[192:195], v[136:139], v[144:147]
    ds_read_b128 v[192:195], v7 offset:57344
    s_waitcnt lgkmcnt(7)
    v_mfma_f32_16x16x32_bf16 v[148:151], v[196:199], v[136:139], v[148:151]
    ds_read_b128 v[196:199], v7 offset:58368
    s_waitcnt lgkmcnt(7)
    v_mfma_f32_16x16x32_bf16 v[152:155], v[200:203], v[136:139], v[152:155]
    ds_read_b128 v[200:203], v7 offset:59392
    s_nop 0
    v_mul_f32_dpp v144, v190, v144 row_newbcast:0 row_mask:0xf bank_mask:0xf
    v_mul_f32_dpp v145, v191, v145 row_newbcast:0 row_mask:0xf bank_mask:0xf
    v_mul_f32_dpp v146, v190, v146 row_newbcast:1 row_mask:0xf bank_mask:0xf
    v_mul_f32_dpp v147, v191, v147 row_newbcast:1 row_mask:0xf bank_mask:0xf
    s_waitcnt lgkmcnt(7)
    v_mfma_f32_16x16x32_bf16 v[156:159], v[204:207], v[136:139], v[156:159]
    ds_read_b128 v[204:207], v7 offset:60416
    v_mul_f32_dpp v148, v190, v148 row_newbcast:2 row_mask:0xf bank_mask:0xf
    v_mul_f32_dpp v149, v191, v149 row_newbcast:2 row_mask:0xf bank_mask:0xf
    v_mul_f32_dpp v150, v190, v150 row_newbcast:3 row_mask:0xf bank_mask:0xf
    v_mul_f32_dpp v151, v191, v151 row_newbcast:3 row_mask:0xf bank_mask:0xf
    s_waitcnt lgkmcnt(7)
    v_mfma_f32_16x16x32_bf16 v[160:163], v[208:211], v[136:139], v[160:163]
    ds_read_b128 v[208:211], v7 offset:61440
    v_mul_f32_dpp v152, v190, v152 row_newbcast:4 row_mask:0xf bank_mask:0xf
    v_mul_f32_dpp v153, v191, v153 row_newbcast:4 row_mask:0xf bank_mask:0xf
    v_mul_f32_dpp v154, v190, v154 row_newbcast:5 row_mask:0xf bank_mask:0xf
    v_mul_f32_dpp v155, v191, v155 row_newbcast:5 row_mask:0xf bank_mask:0xf
    s_waitcnt lgkmcnt(7)
    v_mfma_f32_16x16x32_bf16 v[164:167], v[212:215], v[136:139], v[164:167]
    ds_read_b128 v[212:215], v7 offset:62464
    v_mul_f32_dpp v156, v190, v156 row_newbcast:6 row_mask:0xf bank_mask:0xf
    v_mul_f32_dpp v157, v191, v157 row_newbcast:6 row_mask:0xf bank_mask:0xf
    v_mul_f32_dpp v158, v190, v158 row_newbcast:7 row_mask:0xf bank_mask:0xf
    v_mul_f32_dpp v159, v191, v159 row_newbcast:7 row_mask:0xf bank_mask:0xf
    s_waitcnt lgkmcnt(7)
    v_mfma_f32_16x16x32_bf16 v[168:171], v[216:219], v[136:139], v[168:171]
    ds_read_b128 v[216:219], v7 offset:63488
    v_mul_f32_dpp v160, v190, v160 row_newbcast:8 row_mask:0xf bank_mask:0xf
    v_mul_f32_dpp v161, v191, v161 row_newbcast:8 row_mask:0xf bank_mask:0xf
    v_mul_f32_dpp v162, v190, v162 row_newbcast:9 row_mask:0xf bank_mask:0xf
    v_mul_f32_dpp v163, v191, v163 row_newbcast:9 row_mask:0xf bank_mask:0xf
    s_waitcnt lgkmcnt(7)
    v_mfma_f32_16x16x32_bf16 v[172:175], v[220:223], v[136:139], v[172:175]
    ds_read_b128 v[220:223], v7 offset:64512
    v_mul_f32_dpp v164, v190, v164 row_newbcast:10 row_mask:0xf bank_mask:0xf
    v_mul_f32_dpp v165, v191, v165 row_newbcast:10 row_mask:0xf bank_mask:0xf
    v_mul_f32_dpp v166, v190, v166 row_newbcast:11 row_mask:0xf bank_mask:0xf
    v_mul_f32_dpp v167, v191, v167 row_newbcast:11 row_mask:0xf bank_mask:0xf
    v_mul_f32_dpp v168, v190, v168 row_newbcast:12 row_mask:0xf bank_mask:0xf
    v_mul_f32_dpp v169, v191, v169 row_newbcast:12 row_mask:0xf bank_mask:0xf
    v_mul_f32_dpp v170, v190, v170 row_newbcast:13 row_mask:0xf bank_mask:0xf
    v_mul_f32_dpp v171, v191, v171 row_newbcast:13 row_mask:0xf bank_mask:0xf
    v_mul_f32_dpp v172, v190, v172 row_newbcast:14 row_mask:0xf bank_mask:0xf
    v_mul_f32_dpp v173, v191, v173 row_newbcast:14 row_mask:0xf bank_mask:0xf
    v_mul_f32_dpp v174, v190, v174 row_newbcast:15 row_mask:0xf bank_mask:0xf
    v_mul_f32_dpp v175, v191, v175 row_newbcast:15 row_mask:0xf bank_mask:0xf
    s_waitcnt vmcnt(5)
    s_add_u32 m0, s61, 1792
    s_nop 0
    buffer_load_dwordx4 v1, s[32:35], s6 offen offset:256 nt lds
    s_waitcnt vmcnt(5)
    s_add_u32 m0, s61, 2816
    s_nop 0
    buffer_load_dwordx4 v2, s[32:35], s6 offen offset:256 nt lds
    s_waitcnt vmcnt(5)
    s_waitcnt vmcnt(4) lgkmcnt(0)
    s_barrier
    ds_read_b64_tr_b16 v[140:141], v4 offset:4096
    ds_read_b64_tr_b16 v[142:143], v4 offset:12288
    ds_read_b64_tr_b16 v[112:113], v4 offset:5120
    ds_read_b64_tr_b16 v[114:115], v4 offset:13312
    ds_read_b64_tr_b16 v[116:117], v4 offset:6144
    ds_read_b64_tr_b16 v[118:119], v4 offset:14336
    ds_read_b64_tr_b16 v[120:121], v4 offset:7168
    ds_read_b64_tr_b16 v[122:123], v4 offset:15360
    s_waitcnt lgkmcnt(0)
    s_barrier
    s_add_u32 m0, s61, 3968
    s_nop 0
    buffer_load_dwordx4 v1, s[32:35], s6 offen offset:128 nt lds
    s_add_u32 m0, s61, 4992
    s_nop 0
    buffer_load_dwordx4 v2, s[32:35], s6 offen offset:128 nt lds
    s_add_u32 m0, s61, 5760
    s_nop 0
    buffer_load_dwordx4 v1, s[32:35], s6 offen offset:384 nt lds
    s_add_u32 m0, s61, 6784
    s_nop 0
    buffer_load_dwordx4 v2, s[32:35], s6 offen offset:384 nt lds
    v_mfma_f32_16x16x32_bf16 v[144:147], v[192:195], v[140:143], v[144:147]
    v_mfma_f32_16x16x32_bf16 v[148:151], v[196:199], v[140:143], v[148:151]
    v_mfma_f32_16x16x32_bf16 v[152:155], v[200:203], v[140:143], v[152:155]
    v_mfma_f32_16x16x32_bf16 v[156:159], v[204:207], v[140:143], v[156:159]
    v_mfma_f32_16x16x32_bf16 v[160:163], v[208:211], v[140:143], v[160:163]
    v_mfma_f32_16x16x32_bf16 v[164:167], v[212:215], v[140:143], v[164:167]
    v_mfma_f32_16x16x32_bf16 v[168:171], v[216:219], v[140:143], v[168:171]
    v_mfma_f32_16x16x32_bf16 v[172:175], v[220:223], v[140:143], v[172:175]
    v_pk_mul_f32 v[224:225], v[182:183], v[184:185]
    v_pk_mul_f32 v[224:225], v[224:225], v[186:187]
    v_pk_mul_f32 v[224:225], v[224:225], v[188:189]
    v_pk_mul_f32 v[224:225], v[224:225], v[190:191]
    v_cmp_neq_f32 s[88:89], 0, v224
    v_cmp_neq_f32 s[90:91], 0, v225
    s_nop 0
    s_or_b64 s[88:89], s[88:89], s[90:91]
    s_cbranch_scc1 L_fullA
L_fullA_ret:
    v_readfirstlane_b32 s14, v252
    v_readfirstlane_b32 s86, v253
    s_mov_b64 s[94:95], 0
    s_cmp_eq_u32 s4, 7
    s_cbranch_scc1 L_nopub
    v_pk_mul_f32 v[224:225], v[176:177], v[178:179]
    v_pk_mul_f32 v[224:225], v[224:225], v[180:181]
    v_pk_mul_f32 v[224:225], v[224:225], v[182:183]
    v_pk_mul_f32 v[224:225], v[224:225], v[184:185]
    v_pk_mul_f32 v[224:225], v[224:225], v[186:187]
    v_pk_mul_f32 v[224:225], v[224:225], v[188:189]
    v_pk_mul_f32 v[224:225], v[224:225], v[190:191]
    v_mov_b32 v195, s14
    v_mov_b32 v199, s14
    v_mov_b32 v203, s14
    v_mov_b32 v207, s14
    v_mov_b32 v211, s14
    v_mov_b32 v215, s14
    v_mov_b32 v213, v224
    v_mov_b32 v214, v225
    v_cmp_neq_f32 s[94:95], 0, v224
    v_cmp_neq_f32 s[82:83], 0, v225
    s_nop 0
    s_or_b64 s[94:95], s[94:95], s[82:83]
    s_mul_i32 s82, s7, 6144
    s_add_u32 s82, s82, 0
    s_sub_u32 s82, s6, s60
    s_mul_i32 s83, s5, 6144
    s_add_u32 s82, s82, s83
    s_add_u32 s82, s82, 65536
    s_add_u32 s83, s82, 4096
    v_cvt_pk_bf16_f32 v192, v144, v145
    v_cvt_pk_bf16_f32 v193, v146, v147
    v_cvt_pk_bf16_f32 v194, v148, v149
    v_cvt_pk_bf16_f32 v196, v150, v151
    v_cvt_pk_bf16_f32 v197, v152, v153
    v_cvt_pk_bf16_f32 v198, v154, v155
    v_cvt_pk_bf16_f32 v200, v156, v157
    v_cvt_pk_bf16_f32 v201, v158, v159
    v_cvt_pk_bf16_f32 v202, v160, v161
    v_cvt_pk_bf16_f32 v204, v162, v163
    v_cvt_pk_bf16_f32 v205, v164, v165
    v_cvt_pk_bf16_f32 v206, v166, v167
    v_cvt_pk_bf16_f32 v208, v168, v169
    v_cvt_pk_bf16_f32 v209, v170, v171
    v_cvt_pk_bf16_f32 v210, v172, v173
    v_cvt_pk_bf16_f32 v212, v174, v175
    s_cmp_eq_u32 s86, s15
    s_cbranch_scc1 L_publocal
    buffer_store_dwordx4 v[192:195], v7, s[48:51], s82 offen offset:0 sc1
    buffer_store_dwordx4 v[196:199], v7, s[48:51], s82 offen offset:1024 sc1
    buffer_store_dwordx4 v[200:203], v7, s[48:51], s82 offen offset:2048 sc1
    buffer_store_dwordx4 v[204:207], v7, s[48:51], s82 offen offset:3072 sc1
    buffer_store_dwordx4 v[208:211], v7, s[48:51], s83 offen offset:0 sc1
    buffer_store_dwordx4 v[212:215], v7, s[48:51], s83 offen offset:1024 sc1
    s_branch L_pubdone
L_publocal:
    buffer_store_dwordx4 v[192:195], v7, s[48:51], s82 offen offset:0
    buffer_store_dwordx4 v[196:199], v7, s[48:51], s82 offen offset:1024
    buffer_store_dwordx4 v[200:203], v7, s[48:51], s82 offen offset:2048
    buffer_store_dwordx4 v[204:207], v7, s[48:51], s82 offen offset:3072
    buffer_store_dwordx4 v[208:211], v7, s[48:51], s83 offen offset:0
    buffer_store_dwordx4 v[212:215], v7, s[48:51], s83 offen offset:1024
    s_branch L_pubdone
L_nopub:
    s_mov_b64 exec, 1
    buffer_load_dword v192, off, s[36:39], s6
    buffer_load_dword v192, off, s[36:39], s6
    buffer_load_dword v192, off, s[36:39], s6
    buffer_load_dword v192, off, s[36:39], s6
    buffer_load_dword v192, off, s[36:39], s6
    buffer_load_dword v192, off, s[36:39], s6
    s_mov_b64 exec, -1
    s_nop 12
L_pubdone:
    v_add_u32 v5, s61, v7
    s_sub_u32 s84, s7, 8
    s_mul_i32 s84, s84, 6144
    s_add_u32 s84, s84, 0
    s_sub_u32 s84, s6, s60
    s_mul_i32 s85, s5, 6144
    s_add_u32 s84, s84, s85
    s_cmp_eq_u32 s4, 0
    s_cselect_b32 s84, 0x40000000, s84
    s_add_u32 s85, s84, 4096
    s_waitcnt vmcnt(10)
    ds_read_b128 v[144:147], v12 offset:0
    ds_read_b128 v[148:151], v12 offset:2048
    ds_read_b128 v[152:155], v13 offset:0
    ds_read_b128 v[156:159], v13 offset:2048
    s_waitcnt lgkmcnt(0)
    v_lshlrev_b32 v224, 16, v144
    v_and_b32 v225, 0xffff0000, v144
    v_lshlrev_b32 v226, 16, v145
    v_and_b32 v227, 0xffff0000, v145
    v_lshlrev_b32 v228, 16, v146
    v_and_b32 v229, 0xffff0000, v146
    v_lshlrev_b32 v230, 16, v147
    v_and_b32 v231, 0xffff0000, v147
    v_lshlrev_b32 v232, 16, v148
    v_and_b32 v233, 0xffff0000, v148
    v_lshlrev_b32 v234, 16, v149
    v_and_b32 v235, 0xffff0000, v149
    v_lshlrev_b32 v236, 16, v150
    v_and_b32 v237, 0xffff0000, v150
    v_lshlrev_b32 v238, 16, v151
    v_and_b32 v239, 0xffff0000, v151
    v_pk_mul_f32 v[224:225], v[224:225], v[16:17]
    v_pk_mul_f32 v[226:227], v[226:227], v[18:19]
    v_pk_mul_f32 v[228:229], v[228:229], v[20:21]
    v_pk_mul_f32 v[230:231], v[230:231], v[22:23]
    v_pk_mul_f32 v[232:233], v[232:233], v[24:25]
    v_pk_mul_f32 v[234:235], v[234:235], v[26:27]
    v_pk_mul_f32 v[236:237], v[236:237], v[28:29]
    v_pk_mul_f32 v[238:239], v[238:239], v[30:31]
    v_cvt_pk_bf16_f32 v144, v224, v225
    v_cvt_pk_bf16_f32 v145, v226, v227
    v_cvt_pk_bf16_f32 v146, v228, v229
    v_cvt_pk_bf16_f32 v147, v230, v231
    v_cvt_pk_bf16_f32 v148, v232, v233
    v_cvt_pk_bf16_f32 v149, v234, v235
    v_cvt_pk_bf16_f32 v150, v236, v237
    v_cvt_pk_bf16_f32 v151, v238, v239
    ds_write_b128 v5, v[144:147] offset:0
    ds_write_b128 v5, v[148:151] offset:1024
    v_mfma_f32_16x16x32_bf16 v[240:243], v[80:83], v[144:147], 0
    v_mfma_f32_16x16x32_bf16 v[244:247], v[80:83], v[148:151], 0
    v_mfma_f32_16x16x32_bf16 v[248:251], v[84:87], v[144:147], 0
    v_mfma_f32_16x16x32_bf16 v[252:255], v[84:87], v[148:151], 0
    v_lshlrev_b32 v224, 16, v152
    v_and_b32 v225, 0xffff0000, v152
    v_lshlrev_b32 v226, 16, v153
    v_and_b32 v227, 0xffff0000, v153
    v_lshlrev_b32 v228, 16, v154
    v_and_b32 v229, 0xffff0000, v154
    v_lshlrev_b32 v230, 16, v155
    v_and_b32 v231, 0xffff0000, v155
    v_lshlrev_b32 v232, 16, v156
    v_and_b32 v233, 0xffff0000, v156
    v_lshlrev_b32 v234, 16, v157
    v_and_b32 v235, 0xffff0000, v157
    v_lshlrev_b32 v236, 16, v158
    v_and_b32 v237, 0xffff0000, v158
    v_lshlrev_b32 v238, 16, v159
    v_and_b32 v239, 0xffff0000, v159
    v_pk_mul_f32 v[224:225], v[224:225], v[32:33]
    v_pk_mul_f32 v[226:227], v[226:227], v[34:35]
    v_pk_mul_f32 v[228:229], v[228:229], v[36:37]
    v_pk_mul_f32 v[230:231], v[230:231], v[38:39]
    v_pk_mul_f32 v[232:233], v[232:233], v[40:41]
    v_pk_mul_f32 v[234:235], v[234:235], v[42:43]
    v_pk_mul_f32 v[236:237], v[236:237], v[44:45]
    v_pk_mul_f32 v[238:239], v[238:239], v[46:47]
    v_cvt_pk_bf16_f32 v152, v224, v225
    v_cvt_pk_bf16_f32 v153, v226, v227
    v_cvt_pk_bf16_f32 v154, v228, v229
    v_cvt_pk_bf16_f32 v155, v230, v231
    v_cvt_pk_bf16_f32 v156, v232, v233
    v_cvt_pk_bf16_f32 v157, v234, v235
    v_cvt_pk_bf16_f32 v158, v236, v237
    v_cvt_pk_bf16_f32 v159, v238, v239
    ds_write_b128 v5, v[152:155] offset:2048
    ds_write_b128 v5, v[156:159] offset:3072
    v_mfma_f32_16x16x32_bf16 v[240:243], v[88:91], v[152:155], v[240:243]
    v_mfma_f32_16x16x32_bf16 v[244:247], v[88:91], v[156:159], v[244:247]
    v_mfma_f32_16x16x32_bf16 v[248:251], v[92:95], v[152:155], v[248:251]
    v_mfma_f32_16x16x32_bf16 v[252:255], v[92:95], v[156:159], v[252:255]
    buffer_load_dwordx4 v[192:195], v7, s[48:51], s84 offen offset:0 sc1
    buffer_load_dwordx4 v[196:199], v7, s[48:51], s84 offen offset:1024 sc1
    buffer_load_dwordx4 v[200:203], v7, s[48:51], s84 offen offset:2048 sc1
    buffer_load_dwordx4 v[204:207], v7, s[48:51], s84 offen offset:3072 sc1
    buffer_load_dwordx4 v[208:211], v7, s[48:51], s85 offen offset:0 sc1
    buffer_load_dwordx4 v[212:215], v7, s[48:51], s85 offen offset:1024 sc1
    s_waitcnt vmcnt(12)
    ds_read_b128 v[144:147], v12 offset:4096
    ds_read_b128 v[148:151], v12 offset:6144
    ds_read_b128 v[152:155], v13 offset:4096
    ds_read_b128 v[156:159], v13 offset:6144
    s_waitcnt lgkmcnt(0)
    v_lshlrev_b32 v224, 16, v144
    v_and_b32 v225, 0xffff0000, v144
    v_lshlrev_b32 v226, 16, v145
    v_and_b32 v227, 0xffff0000, v145
    v_lshlrev_b32 v228, 16, v146
    v_and_b32 v229, 0xffff0000, v146
    v_lshlrev_b32 v230, 16, v147
    v_and_b32 v231, 0xffff0000, v147
    v_lshlrev_b32 v232, 16, v148
    v_and_b32 v233, 0xffff0000, v148
    v_lshlrev_b32 v234, 16, v149
    v_and_b32 v235, 0xffff0000, v149
    v_lshlrev_b32 v236, 16, v150
    v_and_b32 v237, 0xffff0000, v150
    v_lshlrev_b32 v238, 16, v151
    v_and_b32 v239, 0xffff0000, v151
    v_pk_mul_f32 v[224:225], v[224:225], v[48:49]
    v_pk_mul_f32 v[226:227], v[226:227], v[50:51]
    v_pk_mul_f32 v[228:229], v[228:229], v[52:53]
    v_pk_mul_f32 v[230:231], v[230:231], v[54:55]
    v_pk_mul_f32 v[232:233], v[232:233], v[56:57]
    v_pk_mul_f32 v[234:235], v[234:235], v[58:59]
    v_pk_mul_f32 v[236:237], v[236:237], v[60:61]
    v_pk_mul_f32 v[238:239], v[238:239], v[62:63]
    v_cvt_pk_bf16_f32 v144, v224, v225
    v_cvt_pk_bf16_f32 v145, v226, v227
    v_cvt_pk_bf16_f32 v146, v228, v229
    v_cvt_pk_bf16_f32 v147, v230, v231
    v_cvt_pk_bf16_f32 v148, v232, v233
    v_cvt_pk_bf16_f32 v149, v234, v235
    v_cvt_pk_bf16_f32 v150, v236, v237
    v_cvt_pk_bf16_f32 v151, v238, v239
    ds_write_b128 v5, v[144:147] offset:4096
    ds_write_b128 v5, v[148:151] offset:5120
    v_mfma_f32_16x16x32_bf16 v[240:243], v[96:99], v[144:147], v[240:243]
    v_mfma_f32_16x16x32_bf16 v[244:247], v[96:99], v[148:151], v[244:247]
    v_mfma_f32_16x16x32_bf16 v[248:251], v[100:103], v[144:147], v[248:251]
    v_mfma_f32_16x16x32_bf16 v[252:255], v[100:103], v[148:151], v[252:255]
    v_lshlrev_b32 v224, 16, v152
    v_and_b32 v225, 0xffff0000, v152
    v_lshlrev_b32 v226, 16, v153
    v_and_b32 v227, 0xffff0000, v153
    v_lshlrev_b32 v228, 16, v154
    v_and_b32 v229, 0xffff0000, v154
    v_lshlrev_b32 v230, 16, v155
    v_and_b32 v231, 0xffff0000, v155
    v_lshlrev_b32 v232, 16, v156
    v_and_b32 v233, 0xffff0000, v156
    v_lshlrev_b32 v234, 16, v157
    v_and_b32 v235, 0xffff0000, v157
    v_lshlrev_b32 v236, 16, v158
    v_and_b32 v237, 0xffff0000, v158
    v_lshlrev_b32 v238, 16, v159
    v_and_b32 v239, 0xffff0000, v159
    v_pk_mul_f32 v[224:225], v[224:225], v[64:65]
    v_pk_mul_f32 v[226:227], v[226:227], v[66:67]
    v_pk_mul_f32 v[228:229], v[228:229], v[68:69]
    v_pk_mul_f32 v[230:231], v[230:231], v[70:71]
    v_pk_mul_f32 v[232:233], v[232:233], v[72:73]
    v_pk_mul_f32 v[234:235], v[234:235], v[74:75]
    v_pk_mul_f32 v[236:237], v[236:237], v[76:77]
    v_pk_mul_f32 v[238:239], v[238:239], v[78:79]
    v_cvt_pk_bf16_f32 v152, v224, v225
    v_cvt_pk_bf16_f32 v153, v226, v227
    v_cvt_pk_bf16_f32 v154, v228, v229
    v_cvt_pk_bf16_f32 v155, v230, v231
    v_cvt_pk_bf16_f32 v156, v232, v233
    v_cvt_pk_bf16_f32 v157, v234, v235
    v_cvt_pk_bf16_f32 v158, v236, v237
    v_cvt_pk_bf16_f32 v159, v238, v239
    ds_write_b128 v5, v[152:155] offset:6144
    ds_write_b128 v5, v[156:159] offset:7168
    v_mfma_f32_16x16x32_bf16 v[240:243], v[104:107], v[152:155], v[240:243]
    v_mfma_f32_16x16x32_bf16 v[244:247], v[104:107], v[156:159], v[244:247]
    v_mfma_f32_16x16x32_bf16 v[248:251], v[108:111], v[152:155], v[248:251]
    v_mfma_f32_16x16x32_bf16 v[252:255], v[108:111], v[156:159], v[252:255]
    s_cmp_lg_u64 s[30:31], 0
    s_cbranch_scc1 L_skipPT
    s_nop 2
    v_cndmask_b32 v240, 0, v240, s[72:73]
    v_cndmask_b32 v241, 0, v241, s[74:75]
    v_cndmask_b32 v242, 0, v242, s[76:77]
    v_cndmask_b32 v243, 0, v243, s[78:79]
    v_cndmask_b32 v244, 0, v244, s[72:73]
    v_cndmask_b32 v245, 0, v245, s[74:75]
    v_cndmask_b32 v246, 0, v246, s[76:77]
    v_cndmask_b32 v247, 0, v247, s[78:79]
    v_cndmask_b32 v248, 0, v248, s[64:65]
    v_cndmask_b32 v249, 0, v249, s[66:67]
    v_cndmask_b32 v250, 0, v250, s[68:69]
    v_cndmask_b32 v251, 0, v251, s[70:71]
    v_cndmask_b32 v252, 0, v252, s[72:73]
    v_cndmask_b32 v253, 0, v253, s[74:75]
    v_cndmask_b32 v254, 0, v254, s[76:77]
    v_cndmask_b32 v255, 0, v255, s[78:79]
    s_lshl_b32 s82, s5, 11
    s_add_u32 s82, s82, 131072
    v_add_u32 v5, s82, v7
    v_cvt_pk_bf16_f32 v224, v240, v248
    v_cvt_pk_bf16_f32 v225, v241, v249
    v_cvt_pk_bf16_f32 v226, v242, v250
    v_cvt_pk_bf16_f32 v227, v243, v251
    ds_write_b128 v5, v[224:227] offset:0
    v_cvt_pk_bf16_f32 v228, v244, v252
    v_cvt_pk_bf16_f32 v229, v245, v253
    v_cvt_pk_bf16_f32 v230, v246, v254
    v_cvt_pk_bf16_f32 v231, v247, v255
    ds_write_b128 v5, v[228:231] offset:1024
L_skipPT:
    v_add_u32 v14, 65536, v7
    v_add_u32 v15, 131072, v7
    ds_read_b128 v[16:19], v7 offset:0
    ds_read_b128 v[20:23], v7 offset:1024
    ds_read_b128 v[24:27], v7 offset:2048
    ds_read_b128 v[28:31], v7 offset:3072
    ds_read_b128 v[32:35], v7 offset:4096
    ds_read_b128 v[36:39], v7 offset:5120
    ds_read_b128 v[40:43], v7 offset:6144
    ds_read_b128 v[44:47], v7 offset:7168
    s_max_u32 s86, s4, 1
    s_mov_b32 s87, 0
    s_cmp_eq_u32 s4, 0
    s_cbranch_scc1 L_lb1ok
L_lb1:
    s_waitcnt vmcnt(0)
    v_cmp_ne_u32 s[88:89], s14, v195
    v_cmp_ne_u32 s[90:91], s14, v199
    s_nop 0
    s_or_b64 s[88:89], s[88:89], s[90:91]
    v_cmp_ne_u32 s[90:91], s14, v203
    s_nop 0
    s_or_b64 s[88:89], s[88:89], s[90:91]
    v_cmp_ne_u32 s[90:91], s14, v207
    s_nop 0
    s_or_b64 s[88:89], s[88:89], s[90:91]
    v_cmp_ne_u32 s[90:91], s14, v211
    s_nop 0
    s_or_b64 s[88:89], s[88:89], s[90:91]
    v_cmp_ne_u32 s[90:91], s14, v215
    s_nop 0
    s_or_b64 s[88:89], s[88:89], s[90:91]
    s_cmp_eq_u64 s[88:89], 0
    s_cbranch_scc1 L_lb1ok
    s_add_u32 s87, s87, 1
    s_cmp_gt_u32 s87, 400000
    s_cbranch_scc1 L_lb1ok
    buffer_load_dwordx4 v[192:195], v7, s[48:51], s84 offen offset:0 sc1
    buffer_load_dwordx4 v[196:199], v7, s[48:51], s84 offen offset:1024 sc1
    buffer_load_dwordx4 v[200:203], v7, s[48:51], s84 offen offset:2048 sc1
    buffer_load_dwordx4 v[204:207], v7, s[48:51], s84 offen offset:3072 sc1
    buffer_load_dwordx4 v[208:211], v7, s[48:51], s85 offen offset:0 sc1
    buffer_load_dwordx4 v[212:215], v7, s[48:51], s85 offen offset:1024 sc1
    s_branch L_lb1
L_lb1ok:
    s_waitcnt vmcnt(0)
    v_lshlrev_b32 v144, 16, v192
    v_and_b32 v145, 0xffff0000, v192
    v_lshlrev_b32 v146, 16, v193
    v_and_b32 v147, 0xffff0000, v193
    v_lshlrev_b32 v148, 16, v194
    v_and_b32 v149, 0xffff0000, v194
    v_lshlrev_b32 v150, 16, v196
    v_and_b32 v151, 0xffff0000, v196
    v_lshlrev_b32 v152, 16, v197
    v_and_b32 v153, 0xffff0000, v197
    v_lshlrev_b32 v154, 16, v198
    v_and_b32 v155, 0xffff0000, v198
    v_lshlrev_b32 v156, 16, v200
    v_and_b32 v157, 0xffff0000, v200
    v_lshlrev_b32 v158, 16, v201
    v_and_b32 v159, 0xffff0000, v201
    v_lshlrev_b32 v160, 16, v202
    v_and_b32 v161, 0xffff0000, v202
    v_lshlrev_b32 v162, 16, v204
    v_and_b32 v163, 0xffff0000, v204
    v_lshlrev_b32 v164, 16, v205
    v_and_b32 v165, 0xffff0000, v205
    v_lshlrev_b32 v166, 16, v206
    v_and_b32 v167, 0xffff0000, v206
    v_lshlrev_b32 v168, 16, v208
    v_and_b32 v169, 0xffff0000, v208
    v_lshlrev_b32 v170, 16, v209
    v_and_b32 v171, 0xffff0000, v209
    v_lshlrev_b32 v172, 16, v210
    v_and_b32 v173, 0xffff0000, v210
    v_lshlrev_b32 v174, 16, v212
    v_and_b32 v175, 0xffff0000, v212
    v_mov_b32 v216, v213
    v_mov_b32 v217, v214
    s_sub_u32 s86, s86, 1
    s_cmp_eq_u32 s86, 0
    s_cbranch_scc1 L_chainB
    v_cmp_neq_f32 s[88:89], 0, v216
    v_cmp_neq_f32 s[90:91], 0, v217
    s_sub_u32 s84, s84, 49152
    s_sub_u32 s85, s85, 49152
    s_or_b64 s[88:89], s[88:89], s[90:91]
    s_cmp_eq_u64 s[88:89], 0
    s_cbranch_scc1 L_chainB
    s_sub_u32 s84, s7, 8
    s_mul_i32 s84, s84, 6144
    s_add_u32 s85, s84, 4096
L_lbload:
    buffer_load_dwordx4 v[192:195], v7, s[56:59], s84 offen offset:0 sc1
    buffer_load_dwordx4 v[196:199], v7, s[56:59], s84 offen offset:1024 sc1
    buffer_load_dwordx4 v[200:203], v7, s[56:59], s84 offen offset:2048 sc1
    buffer_load_dwordx4 v[204:207], v7, s[56:59], s84 offen offset:3072 sc1
    buffer_load_dwordx4 v[208:211], v7, s[56:59], s85 offen offset:0 sc1
    buffer_load_dwordx4 v[212:215], v7, s[56:59], s85 offen offset:1024 sc1
    s_waitcnt vmcnt(0)
    v_cmp_ne_u32 s[88:89], s14, v195
    v_cmp_ne_u32 s[90:91], s14, v199
    s_nop 0
    s_or_b64 s[88:89], s[88:89], s[90:91]
    v_cmp_ne_u32 s[90:91], s14, v203
    s_nop 0
    s_or_b64 s[88:89], s[88:89], s[90:91]
    v_cmp_ne_u32 s[90:91], s14, v207
    s_nop 0
    s_or_b64 s[88:89], s[88:89], s[90:91]
    v_cmp_ne_u32 s[90:91], s14, v211
    s_nop 0
    s_or_b64 s[88:89], s[88:89], s[90:91]
    v_cmp_ne_u32 s[90:91], s14, v215
    s_nop 0
    s_or_b64 s[88:89], s[88:89], s[90:91]
    s_cmp_eq_u64 s[88:89], 0
    s_cbranch_scc1 L_lbok
    s_add_u32 s87, s87, 1
    s_cmp_gt_u32 s87, 400000
    s_cbranch_scc1 L_lbok
    s_branch L_lbload
L_lbok:
    v_lshlrev_b32 v218, 16, v192
    v_and_b32 v219, 0xffff0000, v192
    s_nop 0
    v_fmac_f32_dpp v144, v216, v218 row_newbcast:0 row_mask:0xf bank_mask:0xf
    v_fmac_f32_dpp v145, v217, v219 row_newbcast:0 row_mask:0xf bank_mask:0xf
    v_lshlrev_b32 v220, 16, v193
    v_and_b32 v221, 0xffff0000, v193
    s_nop 0
    v_fmac_f32_dpp v146, v216, v220 row_newbcast:1 row_mask:0xf bank_mask:0xf
    v_fmac_f32_dpp v147, v217, v221 row_newbcast:1 row_mask:0xf bank_mask:0xf
    v_lshlrev_b32 v222, 16, v194
    v_and_b32 v223, 0xffff0000, v194
    s_nop 0
    v_fmac_f32_dpp v148, v216, v222 row_newbcast:2 row_mask:0xf bank_mask:0xf
    v_fmac_f32_dpp v149, v217, v223 row_newbcast:2 row_mask:0xf bank_mask:0xf
    v_lshlrev_b32 v224, 16, v196
    v_and_b32 v225, 0xffff0000, v196
    s_nop 0
    v_fmac_f32_dpp v150, v216, v224 row_newbcast:3 row_mask:0xf bank_mask:0xf
    v_fmac_f32_dpp v151, v217, v225 row_newbcast:3 row_mask:0xf bank_mask:0xf
    v_lshlrev_b32 v218, 16, v197
    v_and_b32 v219, 0xffff0000, v197
    s_nop 0
    v_fmac_f32_dpp v152, v216, v218 row_newbcast:4 row_mask:0xf bank_mask:0xf
    v_fmac_f32_dpp v153, v217, v219 row_newbcast:4 row_mask:0xf bank_mask:0xf
    v_lshlrev_b32 v220, 16, v198
    v_and_b32 v221, 0xffff0000, v198
    s_nop 0
    v_fmac_f32_dpp v154, v216, v220 row_newbcast:5 row_mask:0xf bank_mask:0xf
    v_fmac_f32_dpp v155, v217, v221 row_newbcast:5 row_mask:0xf bank_mask:0xf
    v_lshlrev_b32 v222, 16, v200
    v_and_b32 v223, 0xffff0000, v200
    s_nop 0
    v_fmac_f32_dpp v156, v216, v222 row_newbcast:6 row_mask:0xf bank_mask:0xf
    v_fmac_f32_dpp v157, v217, v223 row_newbcast:6 row_mask:0xf bank_mask:0xf
    v_lshlrev_b32 v224, 16, v201
    v_and_b32 v225, 0xffff0000, v201
    s_nop 0
    v_fmac_f32_dpp v158, v216, v224 row_newbcast:7 row_mask:0xf bank_mask:0xf
    v_fmac_f32_dpp v159, v217, v225 row_newbcast:7 row_mask:0xf bank_mask:0xf
    v_lshlrev_b32 v218, 16, v202
    v_and_b32 v219, 0xffff0000, v202
    s_nop 0
    v_fmac_f32_dpp v160, v216, v218 row_newbcast:8 row_mask:0xf bank_mask:0xf
    v_fmac_f32_dpp v161, v217, v219 row_newbcast:8 row_mask:0xf bank_mask:0xf
    v_lshlrev_b32 v220, 16, v204
    v_and_b32 v221, 0xffff0000, v204
    s_nop 0
    v_fmac_f32_dpp v162, v216, v220 row_newbcast:9 row_mask:0xf bank_mask:0xf
    v_fmac_f32_dpp v163, v217, v221 row_newbcast:9 row_mask:0xf bank_mask:0xf
    v_lshlrev_b32 v222, 16, v205
    v_and_b32 v223, 0xffff0000, v205
    s_nop 0
    v_fmac_f32_dpp v164, v216, v222 row_newbcast:10 row_mask:0xf bank_mask:0xf
    v_fmac_f32_dpp v165, v217, v223 row_newbcast:10 row_mask:0xf bank_mask:0xf
    v_lshlrev_b32 v224, 16, v206
    v_and_b32 v225, 0xffff0000, v206
    s_nop 0
    v_fmac_f32_dpp v166, v216, v224 row_newbcast:11 row_mask:0xf bank_mask:0xf
    v_fmac_f32_dpp v167, v217, v225 row_newbcast:11 row_mask:0xf bank_mask:0xf
    v_lshlrev_b32 v218, 16, v208
    v_and_b32 v219, 0xffff0000, v208
    s_nop 0
    v_fmac_f32_dpp v168, v216, v218 row_newbcast:12 row_mask:0xf bank_mask:0xf
    v_fmac_f32_dpp v169, v217, v219 row_newbcast:12 row_mask:0xf bank_mask:0xf
    v_lshlrev_b32 v220, 16, v209
    v_and_b32 v221, 0xffff0000, v209
    s_nop 0
    v_fmac_f32_dpp v170, v216, v220 row_newbcast:13 row_mask:0xf bank_mask:0xf
    v_fmac_f32_dpp v171, v217, v221 row_newbcast:13 row_mask:0xf bank_mask:0xf
    v_lshlrev_b32 v222, 16, v210
    v_and_b32 v223, 0xffff0000, v210
    s_nop 0
    v_fmac_f32_dpp v172, v216, v222 row_newbcast:14 row_mask:0xf bank_mask:0xf
    v_fmac_f32_dpp v173, v217, v223 row_newbcast:14 row_mask:0xf bank_mask:0xf
    v_lshlrev_b32 v224, 16, v212
    v_and_b32 v225, 0xffff0000, v212
    s_nop 0
    v_fmac_f32_dpp v174, v216, v224 row_newbcast:15 row_mask:0xf bank_mask:0xf
    v_fmac_f32_dpp v175, v217, v225 row_newbcast:15 row_mask:0xf bank_mask:0xf
    s_nop 12
L_chainB:
    s_waitcnt vmcnt(0)
    s_cmp_eq_u64 s[94:95], 0
    s_cbranch_scc1 L_nopk2
    s_mul_i32 s84, s7, 6144
    s_add_u32 s85, s84, 4096
    v_mov_b32 v195, s14
    v_mov_b32 v199, s14
    v_mov_b32 v203, s14
    v_mov_b32 v207, s14
    v_mov_b32 v211, s14
    v_mov_b32 v215, s14
    v_cvt_pk_bf16_f32 v192, v144, v145
    v_cvt_pk_bf16_f32 v193, v146, v147
    v_cvt_pk_bf16_f32 v194, v148, v149
    v_cvt_pk_bf16_f32 v196, v150, v151
    v_cvt_pk_bf16_f32 v197, v152, v153
    v_cvt_pk_bf16_f32 v198, v154, v155
    v_cvt_pk_bf16_f32 v200, v156, v157
    v_cvt_pk_bf16_f32 v201, v158, v159
    v_cvt_pk_bf16_f32 v202, v160, v161
    v_cvt_pk_bf16_f32 v204, v162, v163
    v_cvt_pk_bf16_f32 v205, v164, v165
    v_cvt_pk_bf16_f32 v206, v166, v167
    v_cvt_pk_bf16_f32 v208, v168, v169
    v_cvt_pk_bf16_f32 v209, v170, v171
    v_cvt_pk_bf16_f32 v210, v172, v173
    v_cvt_pk_bf16_f32 v212, v174, v175
    buffer_store_dwordx4 v[192:195], v7, s[56:59], s84 offen offset:0 sc1
    buffer_store_dwordx4 v[196:199], v7, s[56:59], s84 offen offset:1024 sc1
    buffer_store_dwordx4 v[200:203], v7, s[56:59], s84 offen offset:2048 sc1
    buffer_store_dwordx4 v[204:207], v7, s[56:59], s84 offen offset:3072 sc1
    buffer_store_dwordx4 v[208:211], v7, s[56:59], s85 offen offset:0 sc1
    buffer_store_dwordx4 v[212:215], v7, s[56:59], s85 offen offset:1024 sc1
L_nopk2:
    v_and_b32 v248, 15, v0
    v_lshrrev_b32 v249, 5, v0
    s_lshl_b32 s83, s5, 1
    v_add_u32 v249, s83, v249
    v_xor_b32 v249, v249, v248
    v_lshlrev_b32 v249, 4, v249
    v_add_u32 v249, 151808, v249
    v_lshl_add_u32 v4, v248, 9, v249
    v_bfe_u32 v248, v0, 4, 1
    v_lshl_add_u32 v4, v248, 8, v4
    v_lshrrev_b32 v248, 4, v0
    v_lshl_add_u32 v5, v248, 8, v249
    s_lshl_b32 s83, s5, 10
    v_add_u32 v5, s83, v5
    s_sub_u32 s82, s6, s60
    s_add_u32 s82, s82, s83
    v_cvt_pk_bf16_f32 v88, v144, v145
    v_cvt_pk_bf16_f32 v89, v146, v147
    v_cvt_pk_bf16_f32 v90, v148, v149
    v_cvt_pk_bf16_f32 v91, v150, v151
    v_mul_f32_dpp v144, v176, v144 row_newbcast:0 row_mask:0xf bank_mask:0xf
    v_mul_f32_dpp v145, v177, v145 row_newbcast:0 row_mask:0xf bank_mask:0xf
    v_mul_f32_dpp v146, v176, v146 row_newbcast:1 row_mask:0xf bank_mask:0xf
    v_mul_f32_dpp v147, v177, v147 row_newbcast:1 row_mask:0xf bank_mask:0xf
    v_mul_f32_dpp v148, v176, v148 row_newbcast:2 row_mask:0xf bank_mask:0xf
    v_mul_f32_dpp v149, v177, v149 row_newbcast:2 row_mask:0xf bank_mask:0xf
    v_mul_f32_dpp v150, v176, v150 row_newbcast:3 row_mask:0xf bank_mask:0xf
    v_mul_f32_dpp v151, v177, v151 row_newbcast:3 row_mask:0xf bank_mask:0xf
    s_waitcnt lgkmcnt(0)
    s_barrier
    ds_read_b128 v[80:83], v15 offset:0
    ds_read_b128 v[84:87], v15 offset:1024
    ds_read_b128 v[48:51], v14 offset:0
    ds_read_b128 v[52:55], v14 offset:1024
    ds_read_b128 v[56:59], v14 offset:2048
    ds_read_b128 v[60:63], v14 offset:3072
    ds_read_b128 v[64:67], v14 offset:4096
    ds_read_b128 v[68:71], v14 offset:5120
    ds_read_b128 v[72:75], v14 offset:6144
    ds_read_b128 v[76:79], v14 offset:7168
    s_waitcnt lgkmcnt(8)
    v_mfma_f32_16x16x32_bf16 v[144:147], v[16:19], v[112:115], v[144:147]
    ds_read_b128 v[16:19], v7 offset:8192
    v_cvt_pk_bf16_f32 v92, v152, v153
    v_cvt_pk_bf16_f32 v93, v154, v155
    v_mfma_f32_16x16x32_bf16 v[148:151], v[20:23], v[112:115], v[148:151]
    ds_read_b128 v[20:23], v7 offset:9216
    v_cvt_pk_bf16_f32 v94, v156, v157
    v_cvt_pk_bf16_f32 v95, v158, v159
    v_mfma_f32_16x16x32_bf16 v[224:227], v[112:115], v[80:83], 0
    ds_read_b128 v[80:83], v15 offset:2048
    v_mul_f32_dpp v152, v176, v152 row_newbcast:4 row_mask:0xf bank_mask:0xf
    v_mul_f32_dpp v153, v177, v153 row_newbcast:4 row_mask:0xf bank_mask:0xf
    v_mfma_f32_16x16x32_bf16 v[228:231], v[112:115], v[84:87], 0
    ds_read_b128 v[84:87], v15 offset:3072
    v_mul_f32_dpp v154, v176, v154 row_newbcast:5 row_mask:0xf bank_mask:0xf
    v_mul_f32_dpp v155, v177, v155 row_newbcast:5 row_mask:0xf bank_mask:0xf
    s_waitcnt lgkmcnt(11)
    v_mfma_f32_16x16x32_bf16 v[224:227], v[88:91], v[48:51], v[224:227]
    ds_read_b128 v[48:51], v14 offset:8192
    v_mul_f32_dpp v156, v176, v156 row_newbcast:6 row_mask:0xf bank_mask:0xf
    v_mul_f32_dpp v157, v177, v157 row_newbcast:6 row_mask:0xf bank_mask:0xf
    s_waitcnt lgkmcnt(11)
    v_mfma_f32_16x16x32_bf16 v[228:231], v[88:91], v[52:55], v[228:231]
    ds_read_b128 v[52:55], v14 offset:9216
    v_mul_f32_dpp v158, v176, v158 row_newbcast:7 row_mask:0xf bank_mask:0xf
    v_mul_f32_dpp v159, v177, v159 row_newbcast:7 row_mask:0xf bank_mask:0xf
    s_waitcnt lgkmcnt(10)
    v_mfma_f32_16x16x32_bf16 v[152:155], v[24:27], v[112:115], v[152:155]
    ds_read_b128 v[24:27], v7 offset:10240
    v_cvt_pk_bf16_f32 v96, v160, v161
    v_cvt_pk_bf16_f32 v97, v162, v163
    v_cvt_pk_bf16_f32 v98, v164, v165
    v_mfma_f32_16x16x32_bf16 v[156:159], v[28:31], v[112:115], v[156:159]
    ds_read_b128 v[28:31], v7 offset:11264
    v_cvt_pk_bf16_f32 v99, v166, v167
    v_mul_f32_dpp v160, v176, v160 row_newbcast:8 row_mask:0xf bank_mask:0xf
    v_mul_f32_dpp v161, v177, v161 row_newbcast:8 row_mask:0xf bank_mask:0xf
    v_mfma_f32_16x16x32_bf16 v[224:227], v[92:95], v[56:59], v[224:227]
    ds_read_b128 v[56:59], v14 offset:10240
    v_mul_f32_dpp v162, v176, v162 row_newbcast:9 row_mask:0xf bank_mask:0xf
    v_mul_f32_dpp v163, v177, v163 row_newbcast:9 row_mask:0xf bank_mask:0xf
    v_mul_f32_dpp v164, v176, v164 row_newbcast:10 row_mask:0xf bank_mask:0xf
    v_mfma_f32_16x16x32_bf16 v[228:231], v[92:95], v[60:63], v[228:231]
    ds_read_b128 v[60:63], v14 offset:11264
    v_mul_f32_dpp v165, v177, v165 row_newbcast:10 row_mask:0xf bank_mask:0xf
    v_mul_f32_dpp v166, v176, v166 row_newbcast:11 row_mask:0xf bank_mask:0xf
    v_mul_f32_dpp v167, v177, v167 row_newbcast:11 row_mask:0xf bank_mask:0xf
    s_waitcnt lgkmcnt(10)
    v_mfma_f32_16x16x32_bf16 v[160:163], v[32:35], v[112:115], v[160:163]
    ds_read_b128 v[32:35], v7 offset:12288
    v_cvt_pk_bf16_f32 v100, v168, v169
    v_cvt_pk_bf16_f32 v101, v170, v171
    v_cvt_pk_bf16_f32 v102, v172, v173
    v_mfma_f32_16x16x32_bf16 v[164:167], v[36:39], v[112:115], v[164:167]
    ds_read_b128 v[36:39], v7 offset:13312
    v_cvt_pk_bf16_f32 v103, v174, v175
    v_mul_f32_dpp v168, v176, v168 row_newbcast:12 row_mask:0xf bank_mask:0xf
    v_mul_f32_dpp v169, v177, v169 row_newbcast:12 row_mask:0xf bank_mask:0xf
    v_mfma_f32_16x16x32_bf16 v[224:227], v[96:99], v[64:67], v[224:227]
    ds_read_b128 v[64:67], v14 offset:12288
    v_mul_f32_dpp v170, v176, v170 row_newbcast:13 row_mask:0xf bank_mask:0xf
    v_mul_f32_dpp v171, v177, v171 row_newbcast:13 row_mask:0xf bank_mask:0xf
    v_mul_f32_dpp v172, v176, v172 row_newbcast:14 row_mask:0xf bank_mask:0xf
    v_mfma_f32_16x16x32_bf16 v[228:231], v[96:99], v[68:71], v[228:231]
    ds_read_b128 v[68:71], v14 offset:13312
    v_mul_f32_dpp v173, v177, v173 row_newbcast:14 row_mask:0xf bank_mask:0xf
    v_mul_f32_dpp v174, v176, v174 row_newbcast:15 row_mask:0xf bank_mask:0xf
    v_mul_f32_dpp v175, v177, v175 row_newbcast:15 row_mask:0xf bank_mask:0xf
    s_waitcnt lgkmcnt(10)
    v_mfma_f32_16x16x32_bf16 v[168:171], v[40:43], v[112:115], v[168:171]
    ds_read_b128 v[40:43], v7 offset:14336
    v_cvt_pk_bf16_f32 v88, v144, v145
    v_cvt_pk_bf16_f32 v89, v146, v147
    v_cvt_pk_bf16_f32 v90, v148, v149
    v_mfma_f32_16x16x32_bf16 v[172:175], v[44:47], v[112:115], v[172:175]
    ds_read_b128 v[44:47], v7 offset:15360
    v_cvt_pk_bf16_f32 v91, v150, v151
    v_mul_f32_dpp v144, v178, v144 row_newbcast:0 row_mask:0xf bank_mask:0xf
    v_mul_f32_dpp v145, v179, v145 row_newbcast:0 row_mask:0xf bank_mask:0xf
    v_mfma_f32_16x16x32_bf16 v[224:227], v[100:103], v[72:75], v[224:227]
    ds_read_b128 v[72:75], v14 offset:14336
    v_mul_f32_dpp v146, v178, v146 row_newbcast:1 row_mask:0xf bank_mask:0xf
    v_mul_f32_dpp v147, v179, v147 row_newbcast:1 row_mask:0xf bank_mask:0xf
    v_mul_f32_dpp v148, v178, v148 row_newbcast:2 row_mask:0xf bank_mask:0xf
    v_mfma_f32_16x16x32_bf16 v[228:231], v[100:103], v[76:79], v[228:231]
    ds_read_b128 v[76:79], v14 offset:15360
    v_mul_f32_dpp v149, v179, v149 row_newbcast:2 row_mask:0xf bank_mask:0xf
    v_mul_f32_dpp v150, v178, v150 row_newbcast:3 row_mask:0xf bank_mask:0xf
    v_mul_f32_dpp v151, v179, v151 row_newbcast:3 row_mask:0xf bank_mask:0xf
    s_waitcnt lgkmcnt(8)
    v_mfma_f32_16x16x32_bf16 v[144:147], v[16:19], v[116:119], v[144:147]
    ds_read_b128 v[16:19], v7 offset:16384
    v_cvt_pk_bf16_f32 v92, v152, v153
    v_cvt_pk_bf16_f32 v93, v154, v155
    v_mfma_f32_16x16x32_bf16 v[148:151], v[20:23], v[116:119], v[148:151]
    ds_read_b128 v[20:23], v7 offset:17408
    v_cvt_pk_bf16_f32 v94, v156, v157
    v_cvt_pk_bf16_f32 v95, v158, v159
    v_mfma_f32_16x16x32_bf16 v[232:235], v[116:119], v[80:83], 0
    ds_read_b128 v[80:83], v15 offset:4096
    v_mul_f32_dpp v152, v178, v152 row_newbcast:4 row_mask:0xf bank_mask:0xf
    v_mul_f32_dpp v153, v179, v153 row_newbcast:4 row_mask:0xf bank_mask:0xf
    v_mfma_f32_16x16x32_bf16 v[236:239], v[116:119], v[84:87], 0
    ds_read_b128 v[84:87], v15 offset:5120
    v_mul_f32_dpp v154, v178, v154 row_newbcast:5 row_mask:0xf bank_mask:0xf
    v_mul_f32_dpp v155, v179, v155 row_newbcast:5 row_mask:0xf bank_mask:0xf
    v_mfma_f32_16x16x32_bf16 v[232:235], v[88:91], v[48:51], v[232:235]
    ds_read_b128 v[48:51], v14 offset:16384
    v_mul_f32_dpp v156, v178, v156 row_newbcast:6 row_mask:0xf bank_mask:0xf
    v_mul_f32_dpp v157, v179, v157 row_newbcast:6 row_mask:0xf bank_mask:0xf
    v_mfma_f32_16x16x32_bf16 v[236:239], v[88:91], v[52:55], v[236:239]
    ds_read_b128 v[52:55], v14 offset:17408
    v_mul_f32_dpp v158, v178, v158 row_newbcast:7 row_mask:0xf bank_mask:0xf
    v_mul_f32_dpp v159, v179, v159 row_newbcast:7 row_mask:0xf bank_mask:0xf
    s_waitcnt lgkmcnt(10)
    v_mfma_f32_16x16x32_bf16 v[152:155], v[24:27], v[116:119], v[152:155]
    ds_read_b128 v[24:27], v7 offset:18432
    v_cvt_pk_bf16_f32 v96, v160, v161
    v_cvt_pk_bf16_f32 v97, v162, v163
    v_cvt_pk_bf16_f32 v98, v164, v165
    v_cvt_pk_bf16_f32 v99, v166, v167
    v_mul_f32_dpp v160, v178, v160 row_newbcast:8 row_mask:0xf bank_mask:0xf
    v_mfma_f32_16x16x32_bf16 v[156:159], v[28:31], v[116:119], v[156:159]
    ds_read_b128 v[28:31], v7 offset:19456
    v_mul_f32_dpp v161, v179, v161 row_newbcast:8 row_mask:0xf bank_mask:0xf
    v_mul_f32_dpp v162, v178, v162 row_newbcast:9 row_mask:0xf bank_mask:0xf
    v_mul_f32_dpp v163, v179, v163 row_newbcast:9 row_mask:0xf bank_mask:0xf
    v_mul_f32_dpp v164, v178, v164 row_newbcast:10 row_mask:0xf bank_mask:0xf
    v_mul_f32_dpp v165, v179, v165 row_newbcast:10 row_mask:0xf bank_mask:0xf
    v_mfma_f32_16x16x32_bf16 v[232:235], v[92:95], v[56:59], v[232:235]
    ds_read_b128 v[56:59], v14 offset:18432
    v_mul_f32_dpp v166, v178, v166 row_newbcast:11 row_mask:0xf bank_mask:0xf
    v_mul_f32_dpp v167, v179, v167 row_newbcast:11 row_mask:0xf bank_mask:0xf
    v_cvt_pk_bf16_f32 v240, v224, v225
    v_cvt_pk_bf16_f32 v241, v226, v227
    v_cvt_pk_bf16_f32 v242, v228, v229
    v_mfma_f32_16x16x32_bf16 v[236:239], v[92:95], v[60:63], v[236:239]
    ds_read_b128 v[60:63], v14 offset:19456
    v_cvt_pk_bf16_f32 v243, v230, v231
    v_permlane16_swap_b32 v240, v242
    s_nop 0
    v_permlane16_swap_b32 v241, v243
    ds_write_b128 v4, v[240:243] offset:0
    v_add_u32 v4, 4294881024, v4
    s_waitcnt lgkmcnt(10)
    v_mfma_f32_16x16x32_bf16 v[160:163], v[32:35], v[116:119], v[160:163]
    ds_read_b128 v[32:35], v7 offset:20480
    v_cvt_pk_bf16_f32 v100, v168, v169
    v_cvt_pk_bf16_f32 v101, v170, v171
    v_cvt_pk_bf16_f32 v102, v172, v173
    v_mfma_f32_16x16x32_bf16 v[164:167], v[36:39], v[116:119], v[164:167]
    ds_read_b128 v[36:39], v7 offset:21504
    v_cvt_pk_bf16_f32 v103, v174, v175
    v_mul_f32_dpp v168, v178, v168 row_newbcast:12 row_mask:0xf bank_mask:0xf
    v_mul_f32_dpp v169, v179, v169 row_newbcast:12 row_mask:0xf bank_mask:0xf
    v_mfma_f32_16x16x32_bf16 v[232:235], v[96:99], v[64:67], v[232:235]
    ds_read_b128 v[64:67], v14 offset:20480
    v_mul_f32_dpp v170, v178, v170 row_newbcast:13 row_mask:0xf bank_mask:0xf
    v_mul_f32_dpp v171, v179, v171 row_newbcast:13 row_mask:0xf bank_mask:0xf
    v_mul_f32_dpp v172, v178, v172 row_newbcast:14 row_mask:0xf bank_mask:0xf
    v_mfma_f32_16x16x32_bf16 v[236:239], v[96:99], v[68:71], v[236:239]
    ds_read_b128 v[68:71], v14 offset:21504
    v_mul_f32_dpp v173, v179, v173 row_newbcast:14 row_mask:0xf bank_mask:0xf
    v_mul_f32_dpp v174, v178, v174 row_newbcast:15 row_mask:0xf bank_mask:0xf
    v_mul_f32_dpp v175, v179, v175 row_newbcast:15 row_mask:0xf bank_mask:0xf
    s_waitcnt lgkmcnt(4)
    s_barrier
    ds_read_b128 v[248:251], v5 offset:0
    v_add_u32 v5, 4294881024, v5
    v_mfma_f32_16x16x32_bf16 v[168:171], v[40:43], v[116:119], v[168:171]
    ds_read_b128 v[40:43], v7 offset:22528
    v_cvt_pk_bf16_f32 v88, v144, v145
    v_cvt_pk_bf16_f32 v89, v146, v147
    v_cvt_pk_bf16_f32 v90, v148, v149
    v_mfma_f32_16x16x32_bf16 v[172:175], v[44:47], v[116:119], v[172:175]
    ds_read_b128 v[44:47], v7 offset:23552
    v_cvt_pk_bf16_f32 v91, v150, v151
    v_mul_f32_dpp v144, v180, v144 row_newbcast:0 row_mask:0xf bank_mask:0xf
    v_mul_f32_dpp v145, v181, v145 row_newbcast:0 row_mask:0xf bank_mask:0xf
    v_mfma_f32_16x16x32_bf16 v[232:235], v[100:103], v[72:75], v[232:235]
    ds_read_b128 v[72:75], v14 offset:22528
    v_mul_f32_dpp v146, v180, v146 row_newbcast:1 row_mask:0xf bank_mask:0xf
    v_mul_f32_dpp v147, v181, v147 row_newbcast:1 row_mask:0xf bank_mask:0xf
    v_mul_f32_dpp v148, v180, v148 row_newbcast:2 row_mask:0xf bank_mask:0xf
    v_mfma_f32_16x16x32_bf16 v[236:239], v[100:103], v[76:79], v[236:239]
    ds_read_b128 v[76:79], v14 offset:23552
    v_mul_f32_dpp v149, v181, v149 row_newbcast:2 row_mask:0xf bank_mask:0xf
    v_mul_f32_dpp v150, v180, v150 row_newbcast:3 row_mask:0xf bank_mask:0xf
    v_mul_f32_dpp v151, v181, v151 row_newbcast:3 row_mask:0xf bank_mask:0xf
    s_waitcnt lgkmcnt(4)
    buffer_store_dwordx4 v[248:251], v7, s[48:51], s82 offen nt
    s_add_u32 s82, s82, 8192
    v_mfma_f32_16x16x32_bf16 v[144:147], v[16:19], v[120:123], v[144:147]
    ds_read_b128 v[16:19], v7 offset:24576
    v_cvt_pk_bf16_f32 v92, v152, v153
    v_cvt_pk_bf16_f32 v93, v154, v155
    v_mfma_f32_16x16x32_bf16 v[148:151], v[20:23], v[120:123], v[148:151]
    ds_read_b128 v[20:23], v7 offset:25600
    v_cvt_pk_bf16_f32 v94, v156, v157
    v_cvt_pk_bf16_f32 v95, v158, v159
    v_mfma_f32_16x16x32_bf16 v[224:227], v[120:123], v[80:83], 0
    ds_read_b128 v[80:83], v15 offset:6144
    v_mul_f32_dpp v152, v180, v152 row_newbcast:4 row_mask:0xf bank_mask:0xf
    v_mul_f32_dpp v153, v181, v153 row_newbcast:4 row_mask:0xf bank_mask:0xf
    v_mfma_f32_16x16x32_bf16 v[228:231], v[120:123], v[84:87], 0
    ds_read_b128 v[84:87], v15 offset:7168
    v_mul_f32_dpp v154, v180, v154 row_newbcast:5 row_mask:0xf bank_mask:0xf
    v_mul_f32_dpp v155, v181, v155 row_newbcast:5 row_mask:0xf bank_mask:0xf
    v_mfma_f32_16x16x32_bf16 v[224:227], v[88:91], v[48:51], v[224:227]
    ds_read_b128 v[48:51], v14 offset:24576
    v_mul_f32_dpp v156, v180, v156 row_newbcast:6 row_mask:0xf bank_mask:0xf
    v_mul_f32_dpp v157, v181, v157 row_newbcast:6 row_mask:0xf bank_mask:0xf
    v_mfma_f32_16x16x32_bf16 v[228:231], v[88:91], v[52:55], v[228:231]
    ds_read_b128 v[52:55], v14 offset:25600
    v_mul_f32_dpp v158, v180, v158 row_newbcast:7 row_mask:0xf bank_mask:0xf
    v_mul_f32_dpp v159, v181, v159 row_newbcast:7 row_mask:0xf bank_mask:0xf
    v_mfma_f32_16x16x32_bf16 v[152:155], v[24:27], v[120:123], v[152:155]
    ds_read_b128 v[24:27], v7 offset:26624
    v_cvt_pk_bf16_f32 v96, v160, v161
    v_cvt_pk_bf16_f32 v97, v162, v163
    v_cvt_pk_bf16_f32 v98, v164, v165
    v_cvt_pk_bf16_f32 v99, v166, v167
    v_mul_f32_dpp v160, v180, v160 row_newbcast:8 row_mask:0xf bank_mask:0xf
    v_mfma_f32_16x16x32_bf16 v[156:159], v[28:31], v[120:123], v[156:159]
    ds_read_b128 v[28:31], v7 offset:27648
    v_mul_f32_dpp v161, v181, v161 row_newbcast:8 row_mask:0xf bank_mask:0xf
    v_mul_f32_dpp v162, v180, v162 row_newbcast:9 row_mask:0xf bank_mask:0xf
    v_mul_f32_dpp v163, v181, v163 row_newbcast:9 row_mask:0xf bank_mask:0xf
    v_mul_f32_dpp v164, v180, v164 row_newbcast:10 row_mask:0xf bank_mask:0xf
    v_mul_f32_dpp v165, v181, v165 row_newbcast:10 row_mask:0xf bank_mask:0xf
    v_mfma_f32_16x16x32_bf16 v[224:227], v[92:95], v[56:59], v[224:227]
    ds_read_b128 v[56:59], v14 offset:26624
    v_mul_f32_dpp v166, v180, v166 row_newbcast:11 row_mask:0xf bank_mask:0xf
    v_mul_f32_dpp v167, v181, v167 row_newbcast:11 row_mask:0xf bank_mask:0xf
    v_cvt_pk_bf16_f32 v244, v232, v233
    v_cvt_pk_bf16_f32 v245, v234, v235
    v_cvt_pk_bf16_f32 v246, v236, v237
    v_mfma_f32_16x16x32_bf16 v[228:231], v[92:95], v[60:63], v[228:231]
    ds_read_b128 v[60:63], v14 offset:27648
    v_cvt_pk_bf16_f32 v247, v238, v239
    v_permlane16_swap_b32 v244, v246
    s_nop 0
    v_permlane16_swap_b32 v245, v247
    ds_write_b128 v4, v[244:247] offset:8192
    s_waitcnt lgkmcnt(10)
    v_mfma_f32_16x16x32_bf16 v[160:163], v[32:35], v[120:123], v[160:163]
    ds_read_b128 v[32:35], v7 offset:28672
    v_cvt_pk_bf16_f32 v100, v168, v169
    v_cvt_pk_bf16_f32 v101, v170, v171
    v_cvt_pk_bf16_f32 v102, v172, v173
    v_mfma_f32_16x16x32_bf16 v[164:167], v[36:39], v[120:123], v[164:167]
    ds_read_b128 v[36:39], v7 offset:29696
    v_cvt_pk_bf16_f32 v103, v174, v175
    v_mul_f32_dpp v168, v180, v168 row_newbcast:12 row_mask:0xf bank_mask:0xf
    v_mul_f32_dpp v169, v181, v169 row_newbcast:12 row_mask:0xf bank_mask:0xf
    v_mfma_f32_16x16x32_bf16 v[224:227], v[96:99], v[64:67], v[224:227]
    ds_read_b128 v[64:67], v14 offset:28672
    v_mul_f32_dpp v170, v180, v170 row_newbcast:13 row_mask:0xf bank_mask:0xf
    v_mul_f32_dpp v171, v181, v171 row_newbcast:13 row_mask:0xf bank_mask:0xf
    v_mul_f32_dpp v172, v180, v172 row_newbcast:14 row_mask:0xf bank_mask:0xf
    v_mfma_f32_16x16x32_bf16 v[228:231], v[96:99], v[68:71], v[228:231]
    ds_read_b128 v[68:71], v14 offset:29696
    v_mul_f32_dpp v173, v181, v173 row_newbcast:14 row_mask:0xf bank_mask:0xf
    v_mul_f32_dpp v174, v180, v174 row_newbcast:15 row_mask:0xf bank_mask:0xf
    v_mul_f32_dpp v175, v181, v175 row_newbcast:15 row_mask:0xf bank_mask:0xf
    s_waitcnt lgkmcnt(4)
    s_barrier
    ds_read_b128 v[248:251], v5 offset:8192
    v_mfma_f32_16x16x32_bf16 v[168:171], v[40:43], v[120:123], v[168:171]
    ds_read_b128 v[40:43], v7 offset:30720
    v_cvt_pk_bf16_f32 v88, v144, v145
    v_cvt_pk_bf16_f32 v89, v146, v147
    v_cvt_pk_bf16_f32 v90, v148, v149
    v_mfma_f32_16x16x32_bf16 v[172:175], v[44:47], v[120:123], v[172:175]
    ds_read_b128 v[44:47], v7 offset:31744
    v_cvt_pk_bf16_f32 v91, v150, v151
    v_mul_f32_dpp v144, v182, v144 row_newbcast:0 row_mask:0xf bank_mask:0xf
    v_mul_f32_dpp v145, v183, v145 row_newbcast:0 row_mask:0xf bank_mask:0xf
    v_mfma_f32_16x16x32_bf16 v[224:227], v[100:103], v[72:75], v[224:227]
    ds_read_b128 v[72:75], v14 offset:30720
    v_mul_f32_dpp v146, v182, v146 row_newbcast:1 row_mask:0xf bank_mask:0xf
    v_mul_f32_dpp v147, v183, v147 row_newbcast:1 row_mask:0xf bank_mask:0xf
    v_mul_f32_dpp v148, v182, v148 row_newbcast:2 row_mask:0xf bank_mask:0xf
    v_mfma_f32_16x16x32_bf16 v[228:231], v[100:103], v[76:79], v[228:231]
    ds_read_b128 v[76:79], v14 offset:31744
    v_mul_f32_dpp v149, v183, v149 row_newbcast:2 row_mask:0xf bank_mask:0xf
    v_mul_f32_dpp v150, v182, v150 row_newbcast:3 row_mask:0xf bank_mask:0xf
    v_mul_f32_dpp v151, v183, v151 row_newbcast:3 row_mask:0xf bank_mask:0xf
    s_waitcnt lgkmcnt(4)
    buffer_store_dwordx4 v[248:251], v7, s[48:51], s82 offen nt
    s_add_u32 s82, s82, 8192
    v_mfma_f32_16x16x32_bf16 v[144:147], v[16:19], v[124:127], v[144:147]
    ds_read_b128 v[16:19], v7 offset:32768
    v_cvt_pk_bf16_f32 v92, v152, v153
    v_cvt_pk_bf16_f32 v93, v154, v155
    v_mfma_f32_16x16x32_bf16 v[148:151], v[20:23], v[124:127], v[148:151]
    ds_read_b128 v[20:23], v7 offset:33792
    v_cvt_pk_bf16_f32 v94, v156, v157
    v_cvt_pk_bf16_f32 v95, v158, v159
    v_mfma_f32_16x16x32_bf16 v[232:235], v[124:127], v[80:83], 0
    ds_read_b128 v[80:83], v15 offset:8192
    v_mul_f32_dpp v152, v182, v152 row_newbcast:4 row_mask:0xf bank_mask:0xf
    v_mul_f32_dpp v153, v183, v153 row_newbcast:4 row_mask:0xf bank_mask:0xf
    v_mfma_f32_16x16x32_bf16 v[236:239], v[124:127], v[84:87], 0
    ds_read_b128 v[84:87], v15 offset:9216
    v_mul_f32_dpp v154, v182, v154 row_newbcast:5 row_mask:0xf bank_mask:0xf
    v_mul_f32_dpp v155, v183, v155 row_newbcast:5 row_mask:0xf bank_mask:0xf
    v_mfma_f32_16x16x32_bf16 v[232:235], v[88:91], v[48:51], v[232:235]
    ds_read_b128 v[48:51], v14 offset:32768
    v_mul_f32_dpp v156, v182, v156 row_newbcast:6 row_mask:0xf bank_mask:0xf
    v_mul_f32_dpp v157, v183, v157 row_newbcast:6 row_mask:0xf bank_mask:0xf
    v_mfma_f32_16x16x32_bf16 v[236:239], v[88:91], v[52:55], v[236:239]
    ds_read_b128 v[52:55], v14 offset:33792
    v_mul_f32_dpp v158, v182, v158 row_newbcast:7 row_mask:0xf bank_mask:0xf
    v_mul_f32_dpp v159, v183, v159 row_newbcast:7 row_mask:0xf bank_mask:0xf
    v_mfma_f32_16x16x32_bf16 v[152:155], v[24:27], v[124:127], v[152:155]
    ds_read_b128 v[24:27], v7 offset:34816
    v_cvt_pk_bf16_f32 v96, v160, v161
    v_cvt_pk_bf16_f32 v97, v162, v163
    v_cvt_pk_bf16_f32 v98, v164, v165
    v_cvt_pk_bf16_f32 v99, v166, v167
    v_mul_f32_dpp v160, v182, v160 row_newbcast:8 row_mask:0xf bank_mask:0xf
    v_mfma_f32_16x16x32_bf16 v[156:159], v[28:31], v[124:127], v[156:159]
    ds_read_b128 v[28:31], v7 offset:35840
    v_mul_f32_dpp v161, v183, v161 row_newbcast:8 row_mask:0xf bank_mask:0xf
    v_mul_f32_dpp v162, v182, v162 row_newbcast:9 row_mask:0xf bank_mask:0xf
    v_mul_f32_dpp v163, v183, v163 row_newbcast:9 row_mask:0xf bank_mask:0xf
    v_mul_f32_dpp v164, v182, v164 row_newbcast:10 row_mask:0xf bank_mask:0xf
    v_mul_f32_dpp v165, v183, v165 row_newbcast:10 row_mask:0xf bank_mask:0xf
    v_mfma_f32_16x16x32_bf16 v[232:235], v[92:95], v[56:59], v[232:235]
    ds_read_b128 v[56:59], v14 offset:34816
    v_mul_f32_dpp v166, v182, v166 row_newbcast:11 row_mask:0xf bank_mask:0xf
    v_mul_f32_dpp v167, v183, v167 row_newbcast:11 row_mask:0xf bank_mask:0xf
    v_cvt_pk_bf16_f32 v240, v224, v225
    v_cvt_pk_bf16_f32 v241, v226, v227
    v_cvt_pk_bf16_f32 v242, v228, v229
    v_mfma_f32_16x16x32_bf16 v[236:239], v[92:95], v[60:63], v[236:239]
    ds_read_b128 v[60:63], v14 offset:35840
    v_cvt_pk_bf16_f32 v243, v230, v231
    v_permlane16_swap_b32 v240, v242
    s_nop 0
    v_permlane16_swap_b32 v241, v243
    ds_write_b128 v4, v[240:243] offset:16384
    s_waitcnt lgkmcnt(10)
    v_mfma_f32_16x16x32_bf16 v[160:163], v[32:35], v[124:127], v[160:163]
    ds_read_b128 v[32:35], v7 offset:36864
    v_cvt_pk_bf16_f32 v100, v168, v169
    v_cvt_pk_bf16_f32 v101, v170, v171
    v_cvt_pk_bf16_f32 v102, v172, v173
    v_mfma_f32_16x16x32_bf16 v[164:167], v[36:39], v[124:127], v[164:167]
    ds_read_b128 v[36:39], v7 offset:37888
    v_cvt_pk_bf16_f32 v103, v174, v175
    v_mul_f32_dpp v168, v182, v168 row_newbcast:12 row_mask:0xf bank_mask:0xf
    v_mul_f32_dpp v169, v183, v169 row_newbcast:12 row_mask:0xf bank_mask:0xf
    v_mfma_f32_16x16x32_bf16 v[232:235], v[96:99], v[64:67], v[232:235]
    ds_read_b128 v[64:67], v14 offset:36864
    v_mul_f32_dpp v170, v182, v170 row_newbcast:13 row_mask:0xf bank_mask:0xf
    v_mul_f32_dpp v171, v183, v171 row_newbcast:13 row_mask:0xf bank_mask:0xf
    v_mul_f32_dpp v172, v182, v172 row_newbcast:14 row_mask:0xf bank_mask:0xf
    v_mfma_f32_16x16x32_bf16 v[236:239], v[96:99], v[68:71], v[236:239]
    ds_read_b128 v[68:71], v14 offset:37888
    v_mul_f32_dpp v173, v183, v173 row_newbcast:14 row_mask:0xf bank_mask:0xf
    v_mul_f32_dpp v174, v182, v174 row_newbcast:15 row_mask:0xf bank_mask:0xf
    v_mul_f32_dpp v175, v183, v175 row_newbcast:15 row_mask:0xf bank_mask:0xf
    s_waitcnt lgkmcnt(4)
    s_barrier
    ds_read_b128 v[248:251], v5 offset:16384
    v_mfma_f32_16x16x32_bf16 v[168:171], v[40:43], v[124:127], v[168:171]
    ds_read_b128 v[40:43], v7 offset:38912
    v_cvt_pk_bf16_f32 v88, v144, v145
    v_cvt_pk_bf16_f32 v89, v146, v147
    v_cvt_pk_bf16_f32 v90, v148, v149
    v_mfma_f32_16x16x32_bf16 v[172:175], v[44:47], v[124:127], v[172:175]
    ds_read_b128 v[44:47], v7 offset:39936
    v_cvt_pk_bf16_f32 v91, v150, v151
    v_mul_f32_dpp v144, v184, v144 row_newbcast:0 row_mask:0xf bank_mask:0xf
    v_mul_f32_dpp v145, v185, v145 row_newbcast:0 row_mask:0xf bank_mask:0xf
    v_mfma_f32_16x16x32_bf16 v[232:235], v[100:103], v[72:75], v[232:235]
    ds_read_b128 v[72:75], v14 offset:38912
    v_mul_f32_dpp v146, v184, v146 row_newbcast:1 row_mask:0xf bank_mask:0xf
    v_mul_f32_dpp v147, v185, v147 row_newbcast:1 row_mask:0xf bank_mask:0xf
    v_mul_f32_dpp v148, v184, v148 row_newbcast:2 row_mask:0xf bank_mask:0xf
    v_mfma_f32_16x16x32_bf16 v[236:239], v[100:103], v[76:79], v[236:239]
    ds_read_b128 v[76:79], v14 offset:39936
    v_mul_f32_dpp v149, v185, v149 row_newbcast:2 row_mask:0xf bank_mask:0xf
    v_mul_f32_dpp v150, v184, v150 row_newbcast:3 row_mask:0xf bank_mask:0xf
    v_mul_f32_dpp v151, v185, v151 row_newbcast:3 row_mask:0xf bank_mask:0xf
    s_waitcnt lgkmcnt(4)
    buffer_store_dwordx4 v[248:251], v7, s[48:51], s82 offen nt
    s_add_u32 s82, s82, 8192
    v_mfma_f32_16x16x32_bf16 v[144:147], v[16:19], v[128:131], v[144:147]
    ds_read_b128 v[16:19], v7 offset:40960
    v_cvt_pk_bf16_f32 v92, v152, v153
    v_cvt_pk_bf16_f32 v93, v154, v155
    v_mfma_f32_16x16x32_bf16 v[148:151], v[20:23], v[128:131], v[148:151]
    ds_read_b128 v[20:23], v7 offset:41984
    v_cvt_pk_bf16_f32 v94, v156, v157
    v_cvt_pk_bf16_f32 v95, v158, v159
    v_mfma_f32_16x16x32_bf16 v[224:227], v[128:131], v[80:83], 0
    ds_read_b128 v[80:83], v15 offset:10240
    v_mul_f32_dpp v152, v184, v152 row_newbcast:4 row_mask:0xf bank_mask:0xf
    v_mul_f32_dpp v153, v185, v153 row_newbcast:4 row_mask:0xf bank_mask:0xf
    v_mfma_f32_16x16x32_bf16 v[228:231], v[128:131], v[84:87], 0
    ds_read_b128 v[84:87], v15 offset:11264
    v_mul_f32_dpp v154, v184, v154 row_newbcast:5 row_mask:0xf bank_mask:0xf
    v_mul_f32_dpp v155, v185, v155 row_newbcast:5 row_mask:0xf bank_mask:0xf
    v_mfma_f32_16x16x32_bf16 v[224:227], v[88:91], v[48:51], v[224:227]
    ds_read_b128 v[48:51], v14 offset:40960
    v_mul_f32_dpp v156, v184, v156 row_newbcast:6 row_mask:0xf bank_mask:0xf
    v_mul_f32_dpp v157, v185, v157 row_newbcast:6 row_mask:0xf bank_mask:0xf
    v_mfma_f32_16x16x32_bf16 v[228:231], v[88:91], v[52:55], v[228:231]
    ds_read_b128 v[52:55], v14 offset:41984
    v_mul_f32_dpp v158, v184, v158 row_newbcast:7 row_mask:0xf bank_mask:0xf
    v_mul_f32_dpp v159, v185, v159 row_newbcast:7 row_mask:0xf bank_mask:0xf
    v_mfma_f32_16x16x32_bf16 v[152:155], v[24:27], v[128:131], v[152:155]
    ds_read_b128 v[24:27], v7 offset:43008
    v_cvt_pk_bf16_f32 v96, v160, v161
    v_cvt_pk_bf16_f32 v97, v162, v163
    v_cvt_pk_bf16_f32 v98, v164, v165
    v_cvt_pk_bf16_f32 v99, v166, v167
    v_mul_f32_dpp v160, v184, v160 row_newbcast:8 row_mask:0xf bank_mask:0xf
    v_mfma_f32_16x16x32_bf16 v[156:159], v[28:31], v[128:131], v[156:159]
    ds_read_b128 v[28:31], v7 offset:44032
    v_mul_f32_dpp v161, v185, v161 row_newbcast:8 row_mask:0xf bank_mask:0xf
    v_mul_f32_dpp v162, v184, v162 row_newbcast:9 row_mask:0xf bank_mask:0xf
    v_mul_f32_dpp v163, v185, v163 row_newbcast:9 row_mask:0xf bank_mask:0xf
    v_mul_f32_dpp v164, v184, v164 row_newbcast:10 row_mask:0xf bank_mask:0xf
    v_mul_f32_dpp v165, v185, v165 row_newbcast:10 row_mask:0xf bank_mask:0xf
    v_mfma_f32_16x16x32_bf16 v[224:227], v[92:95], v[56:59], v[224:227]
    ds_read_b128 v[56:59], v14 offset:43008
    v_mul_f32_dpp v166, v184, v166 row_newbcast:11 row_mask:0xf bank_mask:0xf
    v_mul_f32_dpp v167, v185, v167 row_newbcast:11 row_mask:0xf bank_mask:0xf
    v_cvt_pk_bf16_f32 v244, v232, v233
    v_cvt_pk_bf16_f32 v245, v234, v235
    v_cvt_pk_bf16_f32 v246, v236, v237
    v_mfma_f32_16x16x32_bf16 v[228:231], v[92:95], v[60:63], v[228:231]
    ds_read_b128 v[60:63], v14 offset:44032
    v_cvt_pk_bf16_f32 v247, v238, v239
    v_permlane16_swap_b32 v244, v246
    s_nop 0
    v_permlane16_swap_b32 v245, v247
    ds_write_b128 v4, v[244:247] offset:24576
    s_waitcnt lgkmcnt(10)
    v_mfma_f32_16x16x32_bf16 v[160:163], v[32:35], v[128:131], v[160:163]
    ds_read_b128 v[32:35], v7 offset:45056
    v_cvt_pk_bf16_f32 v100, v168, v169
    v_cvt_pk_bf16_f32 v101, v170, v171
    v_cvt_pk_bf16_f32 v102, v172, v173
    v_mfma_f32_16x16x32_bf16 v[164:167], v[36:39], v[128:131], v[164:167]
    ds_read_b128 v[36:39], v7 offset:46080
    v_cvt_pk_bf16_f32 v103, v174, v175
    v_mul_f32_dpp v168, v184, v168 row_newbcast:12 row_mask:0xf bank_mask:0xf
    v_mul_f32_dpp v169, v185, v169 row_newbcast:12 row_mask:0xf bank_mask:0xf
    v_mfma_f32_16x16x32_bf16 v[224:227], v[96:99], v[64:67], v[224:227]
    ds_read_b128 v[64:67], v14 offset:45056
    v_mul_f32_dpp v170, v184, v170 row_newbcast:13 row_mask:0xf bank_mask:0xf
    v_mul_f32_dpp v171, v185, v171 row_newbcast:13 row_mask:0xf bank_mask:0xf
    v_mul_f32_dpp v172, v184, v172 row_newbcast:14 row_mask:0xf bank_mask:0xf
    v_mfma_f32_16x16x32_bf16 v[228:231], v[96:99], v[68:71], v[228:231]
    ds_read_b128 v[68:71], v14 offset:46080
    v_mul_f32_dpp v173, v185, v173 row_newbcast:14 row_mask:0xf bank_mask:0xf
    v_mul_f32_dpp v174, v184, v174 row_newbcast:15 row_mask:0xf bank_mask:0xf
    v_mul_f32_dpp v175, v185, v175 row_newbcast:15 row_mask:0xf bank_mask:0xf
    s_waitcnt lgkmcnt(4)
    s_barrier
    ds_read_b128 v[248:251], v5 offset:24576
    v_mfma_f32_16x16x32_bf16 v[168:171], v[40:43], v[128:131], v[168:171]
    ds_read_b128 v[40:43], v7 offset:47104
    v_cvt_pk_bf16_f32 v88, v144, v145
    v_cvt_pk_bf16_f32 v89, v146, v147
    v_cvt_pk_bf16_f32 v90, v148, v149
    v_mfma_f32_16x16x32_bf16 v[172:175], v[44:47], v[128:131], v[172:175]
    ds_read_b128 v[44:47], v7 offset:48128
    v_cvt_pk_bf16_f32 v91, v150, v151
    v_mul_f32_dpp v144, v186, v144 row_newbcast:0 row_mask:0xf bank_mask:0xf
    v_mul_f32_dpp v145, v187, v145 row_newbcast:0 row_mask:0xf bank_mask:0xf
    v_mfma_f32_16x16x32_bf16 v[224:227], v[100:103], v[72:75], v[224:227]
    ds_read_b128 v[72:75], v14 offset:47104
    v_mul_f32_dpp v146, v186, v146 row_newbcast:1 row_mask:0xf bank_mask:0xf
    v_mul_f32_dpp v147, v187, v147 row_newbcast:1 row_mask:0xf bank_mask:0xf
    v_mul_f32_dpp v148, v186, v148 row_newbcast:2 row_mask:0xf bank_mask:0xf
    v_mfma_f32_16x16x32_bf16 v[228:231], v[100:103], v[76:79], v[228:231]
    ds_read_b128 v[76:79], v14 offset:48128
    v_mul_f32_dpp v149, v187, v149 row_newbcast:2 row_mask:0xf bank_mask:0xf
    v_mul_f32_dpp v150, v186, v150 row_newbcast:3 row_mask:0xf bank_mask:0xf
    v_mul_f32_dpp v151, v187, v151 row_newbcast:3 row_mask:0xf bank_mask:0xf
    s_waitcnt lgkmcnt(4)
    buffer_store_dwordx4 v[248:251], v7, s[48:51], s82 offen nt
    s_add_u32 s82, s82, 8192
    v_mfma_f32_16x16x32_bf16 v[144:147], v[16:19], v[132:135], v[144:147]
    ds_read_b128 v[16:19], v7 offset:49152
    v_cvt_pk_bf16_f32 v92, v152, v153
    v_cvt_pk_bf16_f32 v93, v154, v155
    v_mfma_f32_16x16x32_bf16 v[148:151], v[20:23], v[132:135], v[148:151]
    ds_read_b128 v[20:23], v7 offset:50176
    v_cvt_pk_bf16_f32 v94, v156, v157
    v_cvt_pk_bf16_f32 v95, v158, v159
    v_mfma_f32_16x16x32_bf16 v[232:235], v[132:135], v[80:83], 0
    ds_read_b128 v[80:83], v15 offset:12288
    v_mul_f32_dpp v152, v186, v152 row_newbcast:4 row_mask:0xf bank_mask:0xf
    v_mul_f32_dpp v153, v187, v153 row_newbcast:4 row_mask:0xf bank_mask:0xf
    v_mfma_f32_16x16x32_bf16 v[236:239], v[132:135], v[84:87], 0
    ds_read_b128 v[84:87], v15 offset:13312
    v_mul_f32_dpp v154, v186, v154 row_newbcast:5 row_mask:0xf bank_mask:0xf
    v_mul_f32_dpp v155, v187, v155 row_newbcast:5 row_mask:0xf bank_mask:0xf
    v_mfma_f32_16x16x32_bf16 v[232:235], v[88:91], v[48:51], v[232:235]
    ds_read_b128 v[48:51], v14 offset:49152
    v_mul_f32_dpp v156, v186, v156 row_newbcast:6 row_mask:0xf bank_mask:0xf
    v_mul_f32_dpp v157, v187, v157 row_newbcast:6 row_mask:0xf bank_mask:0xf
    v_mfma_f32_16x16x32_bf16 v[236:239], v[88:91], v[52:55], v[236:239]
    ds_read_b128 v[52:55], v14 offset:50176
    v_mul_f32_dpp v158, v186, v158 row_newbcast:7 row_mask:0xf bank_mask:0xf
    v_mul_f32_dpp v159, v187, v159 row_newbcast:7 row_mask:0xf bank_mask:0xf
    v_mfma_f32_16x16x32_bf16 v[152:155], v[24:27], v[132:135], v[152:155]
    ds_read_b128 v[24:27], v7 offset:51200
    v_cvt_pk_bf16_f32 v96, v160, v161
    v_cvt_pk_bf16_f32 v97, v162, v163
    v_cvt_pk_bf16_f32 v98, v164, v165
    v_cvt_pk_bf16_f32 v99, v166, v167
    v_mul_f32_dpp v160, v186, v160 row_newbcast:8 row_mask:0xf bank_mask:0xf
    v_mfma_f32_16x16x32_bf16 v[156:159], v[28:31], v[132:135], v[156:159]
    ds_read_b128 v[28:31], v7 offset:52224
    v_mul_f32_dpp v161, v187, v161 row_newbcast:8 row_mask:0xf bank_mask:0xf
    v_mul_f32_dpp v162, v186, v162 row_newbcast:9 row_mask:0xf bank_mask:0xf
    v_mul_f32_dpp v163, v187, v163 row_newbcast:9 row_mask:0xf bank_mask:0xf
    v_mul_f32_dpp v164, v186, v164 row_newbcast:10 row_mask:0xf bank_mask:0xf
    v_mul_f32_dpp v165, v187, v165 row_newbcast:10 row_mask:0xf bank_mask:0xf
    v_mfma_f32_16x16x32_bf16 v[232:235], v[92:95], v[56:59], v[232:235]
    ds_read_b128 v[56:59], v14 offset:51200
    v_mul_f32_dpp v166, v186, v166 row_newbcast:11 row_mask:0xf bank_mask:0xf
    v_mul_f32_dpp v167, v187, v167 row_newbcast:11 row_mask:0xf bank_mask:0xf
    v_cvt_pk_bf16_f32 v240, v224, v225
    v_cvt_pk_bf16_f32 v241, v226, v227
    v_cvt_pk_bf16_f32 v242, v228, v229
    v_mfma_f32_16x16x32_bf16 v[236:239], v[92:95], v[60:63], v[236:239]
    ds_read_b128 v[60:63], v14 offset:52224
    v_cvt_pk_bf16_f32 v243, v230, v231
    v_permlane16_swap_b32 v240, v242
    s_nop 0
    v_permlane16_swap_b32 v241, v243
    ds_write_b128 v4, v[240:243] offset:32768
    s_waitcnt lgkmcnt(10)
    v_mfma_f32_16x16x32_bf16 v[160:163], v[32:35], v[132:135], v[160:163]
    ds_read_b128 v[32:35], v7 offset:53248
    v_cvt_pk_bf16_f32 v100, v168, v169
    v_cvt_pk_bf16_f32 v101, v170, v171
    v_cvt_pk_bf16_f32 v102, v172, v173
    v_mfma_f32_16x16x32_bf16 v[164:167], v[36:39], v[132:135], v[164:167]
    ds_read_b128 v[36:39], v7 offset:54272
    v_cvt_pk_bf16_f32 v103, v174, v175
    v_mul_f32_dpp v168, v186, v168 row_newbcast:12 row_mask:0xf bank_mask:0xf
    v_mul_f32_dpp v169, v187, v169 row_newbcast:12 row_mask:0xf bank_mask:0xf
    v_mfma_f32_16x16x32_bf16 v[232:235], v[96:99], v[64:67], v[232:235]
    ds_read_b128 v[64:67], v14 offset:53248
    v_mul_f32_dpp v170, v186, v170 row_newbcast:13 row_mask:0xf bank_mask:0xf
    v_mul_f32_dpp v171, v187, v171 row_newbcast:13 row_mask:0xf bank_mask:0xf
    v_mul_f32_dpp v172, v186, v172 row_newbcast:14 row_mask:0xf bank_mask:0xf
    v_mfma_f32_16x16x32_bf16 v[236:239], v[96:99], v[68:71], v[236:239]
    ds_read_b128 v[68:71], v14 offset:54272
    v_mul_f32_dpp v173, v187, v173 row_newbcast:14 row_mask:0xf bank_mask:0xf
    v_mul_f32_dpp v174, v186, v174 row_newbcast:15 row_mask:0xf bank_mask:0xf
    v_mul_f32_dpp v175, v187, v175 row_newbcast:15 row_mask:0xf bank_mask:0xf
    s_waitcnt lgkmcnt(4)
    s_barrier
    ds_read_b128 v[248:251], v5 offset:32768
    v_mfma_f32_16x16x32_bf16 v[168:171], v[40:43], v[132:135], v[168:171]
    ds_read_b128 v[40:43], v7 offset:55296
    v_cvt_pk_bf16_f32 v88, v144, v145
    v_cvt_pk_bf16_f32 v89, v146, v147
    v_cvt_pk_bf16_f32 v90, v148, v149
    v_mfma_f32_16x16x32_bf16 v[172:175], v[44:47], v[132:135], v[172:175]
    ds_read_b128 v[44:47], v7 offset:56320
    v_cvt_pk_bf16_f32 v91, v150, v151
    v_mul_f32_dpp v144, v188, v144 row_newbcast:0 row_mask:0xf bank_mask:0xf
    v_mul_f32_dpp v145, v189, v145 row_newbcast:0 row_mask:0xf bank_mask:0xf
    v_mfma_f32_16x16x32_bf16 v[232:235], v[100:103], v[72:75], v[232:235]
    ds_read_b128 v[72:75], v14 offset:55296
    v_mul_f32_dpp v146, v188, v146 row_newbcast:1 row_mask:0xf bank_mask:0xf
    v_mul_f32_dpp v147, v189, v147 row_newbcast:1 row_mask:0xf bank_mask:0xf
    v_mul_f32_dpp v148, v188, v148 row_newbcast:2 row_mask:0xf bank_mask:0xf
    v_mfma_f32_16x16x32_bf16 v[236:239], v[100:103], v[76:79], v[236:239]
    ds_read_b128 v[76:79], v14 offset:56320
    v_mul_f32_dpp v149, v189, v149 row_newbcast:2 row_mask:0xf bank_mask:0xf
    v_mul_f32_dpp v150, v188, v150 row_newbcast:3 row_mask:0xf bank_mask:0xf
    v_mul_f32_dpp v151, v189, v151 row_newbcast:3 row_mask:0xf bank_mask:0xf
    s_waitcnt lgkmcnt(4)
    buffer_store_dwordx4 v[248:251], v7, s[48:51], s82 offen nt
    s_add_u32 s82, s82, 8192
    v_mfma_f32_16x16x32_bf16 v[144:147], v[16:19], v[136:139], v[144:147]
    v_cvt_pk_bf16_f32 v92, v152, v153
    v_cvt_pk_bf16_f32 v93, v154, v155
    v_mfma_f32_16x16x32_bf16 v[148:151], v[20:23], v[136:139], v[148:151]
    v_cvt_pk_bf16_f32 v94, v156, v157
    v_cvt_pk_bf16_f32 v95, v158, v159
    v_mfma_f32_16x16x32_bf16 v[224:227], v[136:139], v[80:83], 0
    ds_read_b128 v[80:83], v15 offset:14336
    v_mul_f32_dpp v152, v188, v152 row_newbcast:4 row_mask:0xf bank_mask:0xf
    v_mul_f32_dpp v153, v189, v153 row_newbcast:4 row_mask:0xf bank_mask:0xf
    v_mfma_f32_16x16x32_bf16 v[228:231], v[136:139], v[84:87], 0
    ds_read_b128 v[84:87], v15 offset:15360
    v_mul_f32_dpp v154, v188, v154 row_newbcast:5 row_mask:0xf bank_mask:0xf
    v_mul_f32_dpp v155, v189, v155 row_newbcast:5 row_mask:0xf bank_mask:0xf
    v_mfma_f32_16x16x32_bf16 v[224:227], v[88:91], v[48:51], v[224:227]
    ds_read_b128 v[48:51], v14 offset:57344
    v_mul_f32_dpp v156, v188, v156 row_newbcast:6 row_mask:0xf bank_mask:0xf
    v_mul_f32_dpp v157, v189, v157 row_newbcast:6 row_mask:0xf bank_mask:0xf
    v_mfma_f32_16x16x32_bf16 v[228:231], v[88:91], v[52:55], v[228:231]
    ds_read_b128 v[52:55], v14 offset:58368
    v_mul_f32_dpp v158, v188, v158 row_newbcast:7 row_mask:0xf bank_mask:0xf
    v_mul_f32_dpp v159, v189, v159 row_newbcast:7 row_mask:0xf bank_mask:0xf
    v_mfma_f32_16x16x32_bf16 v[152:155], v[24:27], v[136:139], v[152:155]
    v_cvt_pk_bf16_f32 v96, v160, v161
    v_cvt_pk_bf16_f32 v97, v162, v163
    v_cvt_pk_bf16_f32 v98, v164, v165
    v_cvt_pk_bf16_f32 v99, v166, v167
    v_mul_f32_dpp v160, v188, v160 row_newbcast:8 row_mask:0xf bank_mask:0xf
    v_mfma_f32_16x16x32_bf16 v[156:159], v[28:31], v[136:139], v[156:159]
    v_mul_f32_dpp v161, v189, v161 row_newbcast:8 row_mask:0xf bank_mask:0xf
    v_mul_f32_dpp v162, v188, v162 row_newbcast:9 row_mask:0xf bank_mask:0xf
    v_mul_f32_dpp v163, v189, v163 row_newbcast:9 row_mask:0xf bank_mask:0xf
    v_mul_f32_dpp v164, v188, v164 row_newbcast:10 row_mask:0xf bank_mask:0xf
    v_mul_f32_dpp v165, v189, v165 row_newbcast:10 row_mask:0xf bank_mask:0xf
    v_mfma_f32_16x16x32_bf16 v[224:227], v[92:95], v[56:59], v[224:227]
    ds_read_b128 v[56:59], v14 offset:59392
    v_mul_f32_dpp v166, v188, v166 row_newbcast:11 row_mask:0xf bank_mask:0xf
    v_mul_f32_dpp v167, v189, v167 row_newbcast:11 row_mask:0xf bank_mask:0xf
    v_cvt_pk_bf16_f32 v244, v232, v233
    v_cvt_pk_bf16_f32 v245, v234, v235
    v_cvt_pk_bf16_f32 v246, v236, v237
    v_mfma_f32_16x16x32_bf16 v[228:231], v[92:95], v[60:63], v[228:231]
    ds_read_b128 v[60:63], v14 offset:60416
    v_cvt_pk_bf16_f32 v247, v238, v239
    v_permlane16_swap_b32 v244, v246
    s_nop 0
    v_permlane16_swap_b32 v245, v247
    ds_write_b128 v4, v[244:247] offset:40960
    s_waitcnt lgkmcnt(10)
    v_mfma_f32_16x16x32_bf16 v[160:163], v[32:35], v[136:139], v[160:163]
    v_cvt_pk_bf16_f32 v100, v168, v169
    v_cvt_pk_bf16_f32 v101, v170, v171
    v_cvt_pk_bf16_f32 v102, v172, v173
    v_mfma_f32_16x16x32_bf16 v[164:167], v[36:39], v[136:139], v[164:167]
    v_cvt_pk_bf16_f32 v103, v174, v175
    v_mul_f32_dpp v168, v188, v168 row_newbcast:12 row_mask:0xf bank_mask:0xf
    v_mul_f32_dpp v169, v189, v169 row_newbcast:12 row_mask:0xf bank_mask:0xf
    v_mfma_f32_16x16x32_bf16 v[224:227], v[96:99], v[64:67], v[224:227]
    ds_read_b128 v[64:67], v14 offset:61440
    v_mul_f32_dpp v170, v188, v170 row_newbcast:13 row_mask:0xf bank_mask:0xf
    v_mul_f32_dpp v171, v189, v171 row_newbcast:13 row_mask:0xf bank_mask:0xf
    v_mul_f32_dpp v172, v188, v172 row_newbcast:14 row_mask:0xf bank_mask:0xf
    v_mfma_f32_16x16x32_bf16 v[228:231], v[96:99], v[68:71], v[228:231]
    ds_read_b128 v[68:71], v14 offset:62464
    v_mul_f32_dpp v173, v189, v173 row_newbcast:14 row_mask:0xf bank_mask:0xf
    v_mul_f32_dpp v174, v188, v174 row_newbcast:15 row_mask:0xf bank_mask:0xf
    v_mul_f32_dpp v175, v189, v175 row_newbcast:15 row_mask:0xf bank_mask:0xf
    s_waitcnt lgkmcnt(2)
    s_barrier
    ds_read_b128 v[248:251], v5 offset:40960
    v_mfma_f32_16x16x32_bf16 v[168:171], v[40:43], v[136:139], v[168:171]
    v_cvt_pk_bf16_f32 v88, v144, v145
    v_mfma_f32_16x16x32_bf16 v[172:175], v[44:47], v[136:139], v[172:175]
    v_cvt_pk_bf16_f32 v89, v146, v147
    v_mfma_f32_16x16x32_bf16 v[224:227], v[100:103], v[72:75], v[224:227]
    ds_read_b128 v[72:75], v14 offset:63488
    v_cvt_pk_bf16_f32 v90, v148, v149
    v_mfma_f32_16x16x32_bf16 v[228:231], v[100:103], v[76:79], v[228:231]
    ds_read_b128 v[76:79], v14 offset:64512
    v_cvt_pk_bf16_f32 v91, v150, v151
    s_waitcnt lgkmcnt(2)
    buffer_store_dwordx4 v[248:251], v7, s[48:51], s82 offen nt
    s_add_u32 s82, s82, 8192
    v_mfma_f32_16x16x32_bf16 v[232:235], v[140:143], v[80:83], 0
    v_cvt_pk_bf16_f32 v92, v152, v153
    v_mfma_f32_16x16x32_bf16 v[236:239], v[140:143], v[84:87], 0
    v_cvt_pk_bf16_f32 v93, v154, v155
    v_mfma_f32_16x16x32_bf16 v[232:235], v[88:91], v[48:51], v[232:235]
    v_cvt_pk_bf16_f32 v94, v156, v157
    v_mfma_f32_16x16x32_bf16 v[236:239], v[88:91], v[52:55], v[236:239]
    v_cvt_pk_bf16_f32 v95, v158, v159
    s_nop 1
    v_mfma_f32_16x16x32_bf16 v[232:235], v[92:95], v[56:59], v[232:235]
    v_cvt_pk_bf16_f32 v96, v160, v161
    v_cvt_pk_bf16_f32 v97, v162, v163
    v_cvt_pk_bf16_f32 v98, v164, v165
    v_cvt_pk_bf16_f32 v99, v166, v167
    v_cvt_pk_bf16_f32 v240, v224, v225
    v_cvt_pk_bf16_f32 v241, v226, v227
    v_mfma_f32_16x16x32_bf16 v[236:239], v[92:95], v[60:63], v[236:239]
    v_cvt_pk_bf16_f32 v242, v228, v229
    v_cvt_pk_bf16_f32 v243, v230, v231
    s_nop 0
    v_permlane16_swap_b32 v240, v242
    v_permlane16_swap_b32 v241, v243
    ds_write_b128 v4, v[240:243] offset:49152
    v_mfma_f32_16x16x32_bf16 v[232:235], v[96:99], v[64:67], v[232:235]
    v_cvt_pk_bf16_f32 v100, v168, v169
    v_cvt_pk_bf16_f32 v101, v170, v171
    v_mfma_f32_16x16x32_bf16 v[236:239], v[96:99], v[68:71], v[236:239]
    v_cvt_pk_bf16_f32 v102, v172, v173
    v_cvt_pk_bf16_f32 v103, v174, v175
    s_waitcnt lgkmcnt(0)
    s_barrier
    ds_read_b128 v[248:251], v5 offset:49152
    v_mfma_f32_16x16x32_bf16 v[232:235], v[100:103], v[72:75], v[232:235]
    v_mfma_f32_16x16x32_bf16 v[236:239], v[100:103], v[76:79], v[236:239]
    s_waitcnt lgkmcnt(0)
    buffer_store_dwordx4 v[248:251], v7, s[48:51], s82 offen nt
    s_add_u32 s82, s82, 8192
    s_nop 3
    v_cvt_pk_bf16_f32 v244, v232, v233
    v_cvt_pk_bf16_f32 v245, v234, v235
    v_cvt_pk_bf16_f32 v246, v236, v237
    v_cvt_pk_bf16_f32 v247, v238, v239
    s_nop 0
    v_permlane16_swap_b32 v244, v246
    v_permlane16_swap_b32 v245, v247
    ds_write_b128 v4, v[244:247] offset:57344
    s_waitcnt lgkmcnt(0)
    s_barrier
    ds_read_b128 v[248:251], v5 offset:57344
    s_waitcnt lgkmcnt(0)
    buffer_store_dwordx4 v[248:251], v7, s[48:51], s82 offen nt
    s_add_u32 s82, s82, 8192
    s_endpgm
    s_nop 12
L_fbA:
    s_waitcnt vmcnt(0) lgkmcnt(0)
    v_and_b32 v104, 15, v0
    v_lshlrev_b32 v104, 9, v104
    v_lshrrev_b32 v105, 4, v0
    v_lshl_add_u32 v104, v105, 4, v104
    s_lshl_b32 s82, s5, 11
    s_add_u32 s82, s82, 131072
    v_add_u32 v105, s82, v7
    v_mov_b32 v80, 0
    v_mov_b32 v81, 0
    v_mov_b32 v82, 0
    v_mov_b32 v83, 0
    v_mov_b32 v84, 0
    v_mov_b32 v85, 0
    v_mov_b32 v86, 0
    v_mov_b32 v87, 0
    v_mov_b32 v88, 0
    v_mov_b32 v89, 0
    v_mov_b32 v90, 0
    v_mov_b32 v91, 0
    v_mov_b32 v92, 0
    v_mov_b32 v93, 0
    v_mov_b32 v94, 0
    v_mov_b32 v95, 0
    buffer_load_dwordx4 v[224:227], v104, s[44:47], s6 offen offset:0
    buffer_load_dwordx4 v[228:231], v104, s[44:47], s6 offen offset:256
    buffer_load_dwordx4 v[232:235], v104, s[36:39], s6 offen offset:0
    buffer_load_dwordx4 v[236:239], v104, s[36:39], s6 offen offset:256
    buffer_load_dwordx4 v[208:211], v104, s[32:35], s6 offen offset:0
    buffer_load_dwordx4 v[212:215], v104, s[32:35], s6 offen offset:256
    s_waitcnt vmcnt(0)
    v_lshlrev_b32 v112, 16, v224
    v_and_b32 v113, 0xffff0000, v224
    v_lshlrev_b32 v114, 16, v225
    v_and_b32 v115, 0xffff0000, v225
    v_lshlrev_b32 v116, 16, v226
    v_and_b32 v117, 0xffff0000, v226
    v_lshlrev_b32 v118, 16, v227
    v_and_b32 v119, 0xffff0000, v227
    v_lshlrev_b32 v120, 16, v228
    v_and_b32 v121, 0xffff0000, v228
    v_lshlrev_b32 v122, 16, v229
    v_and_b32 v123, 0xffff0000, v229
    v_lshlrev_b32 v124, 16, v230
    v_and_b32 v125, 0xffff0000, v230
    v_lshlrev_b32 v126, 16, v231
    v_and_b32 v127, 0xffff0000, v231
    v_lshlrev_b32 v144, 16, v232
    v_and_b32 v145, 0xffff0000, v232
    v_lshlrev_b32 v146, 16, v233
    v_and_b32 v147, 0xffff0000, v233
    v_lshlrev_b32 v148, 16, v234
    v_and_b32 v149, 0xffff0000, v234
    v_lshlrev_b32 v150, 16, v235
    v_and_b32 v151, 0xffff0000, v235
    v_lshlrev_b32 v152, 16, v236
    v_and_b32 v153, 0xffff0000, v236
    v_lshlrev_b32 v154, 16, v237
    v_and_b32 v155, 0xffff0000, v237
    v_lshlrev_b32 v156, 16, v238
    v_and_b32 v157, 0xffff0000, v238
    v_lshlrev_b32 v158, 16, v239
    v_and_b32 v159, 0xffff0000, v239
    v_lshlrev_b32 v160, 16, v208
    v_and_b32 v161, 0xffff0000, v208
    v_lshlrev_b32 v162, 16, v209
    v_and_b32 v163, 0xffff0000, v209
    v_lshlrev_b32 v164, 16, v210
    v_and_b32 v165, 0xffff0000, v210
    v_lshlrev_b32 v166, 16, v211
    v_and_b32 v167, 0xffff0000, v211
    v_lshlrev_b32 v168, 16, v212
    v_and_b32 v169, 0xffff0000, v212
    v_lshlrev_b32 v170, 16, v213
    v_and_b32 v171, 0xffff0000, v213
    v_lshlrev_b32 v172, 16, v214
    v_and_b32 v173, 0xffff0000, v214
    v_lshlrev_b32 v174, 16, v215
    v_and_b32 v175, 0xffff0000, v215
    v_pk_mul_f32 v[144:145], v[144:145], s[12:13]
    v_pk_mul_f32 v[146:147], v[146:147], s[12:13]
    v_pk_mul_f32 v[148:149], v[148:149], s[12:13]
    v_pk_mul_f32 v[150:151], v[150:151], s[12:13]
    v_pk_mul_f32 v[152:153], v[152:153], s[12:13]
    v_pk_mul_f32 v[154:155], v[154:155], s[12:13]
    v_pk_mul_f32 v[156:157], v[156:157], s[12:13]
    v_pk_mul_f32 v[158:159], v[158:159], s[12:13]
    v_cvt_pk_bf16_f32 v232, v144, v145
    v_cvt_pk_bf16_f32 v233, v146, v147
    v_cvt_pk_bf16_f32 v234, v148, v149
    v_cvt_pk_bf16_f32 v235, v150, v151
    v_cvt_pk_bf16_f32 v236, v152, v153
    v_cvt_pk_bf16_f32 v237, v154, v155
    v_cvt_pk_bf16_f32 v238, v156, v157
    v_cvt_pk_bf16_f32 v239, v158, v159
    v_pk_mul_f32 v[112:113], v[112:113], s[8:9]
    v_pk_mul_f32 v[114:115], v[114:115], s[8:9]
    v_pk_mul_f32 v[116:117], v[116:117], s[8:9]
    v_pk_mul_f32 v[118:119], v[118:119], s[8:9]
    v_pk_mul_f32 v[120:121], v[120:121], s[8:9]
    v_pk_mul_f32 v[122:123], v[122:123], s[8:9]
    v_pk_mul_f32 v[124:125], v[124:125], s[8:9]
    v_pk_mul_f32 v[126:127], v[126:127], s[8:9]
    v_exp_f32 v112, v112
    v_exp_f32 v113, v113
    v_exp_f32 v114, v114
    v_exp_f32 v115, v115
    v_exp_f32 v116, v116
    v_exp_f32 v117, v117
    v_exp_f32 v118, v118
    v_exp_f32 v119, v119
    v_exp_f32 v120, v120
    v_exp_f32 v121, v121
    v_exp_f32 v122, v122
    v_exp_f32 v123, v123
    v_exp_f32 v124, v124
    v_exp_f32 v125, v125
    v_exp_f32 v126, v126
    v_exp_f32 v127, v127
    v_pk_add_f32 v[112:113], v[112:113], s[10:11]
    v_pk_add_f32 v[114:115], v[114:115], s[10:11]
    v_pk_add_f32 v[116:117], v[116:117], s[10:11]
    v_pk_add_f32 v[118:119], v[118:119], s[10:11]
    v_pk_add_f32 v[120:121], v[120:121], s[10:11]
    v_pk_add_f32 v[122:123], v[122:123], s[10:11]
    v_pk_add_f32 v[124:125], v[124:125], s[10:11]
    v_pk_add_f32 v[126:127], v[126:127], s[10:11]
    v_rcp_f32 v112, v112
    v_rcp_f32 v113, v113
    v_rcp_f32 v114, v114
    v_rcp_f32 v115, v115
    v_rcp_f32 v116, v116
    v_rcp_f32 v117, v117
    v_rcp_f32 v118, v118
    v_rcp_f32 v119, v119
    v_rcp_f32 v120, v120
    v_rcp_f32 v121, v121
    v_rcp_f32 v122, v122
    v_rcp_f32 v123, v123
    v_rcp_f32 v124, v124
    v_rcp_f32 v125, v125
    v_rcp_f32 v126, v126
    v_rcp_f32 v127, v127
    v_pk_mul_f32 v[136:137], v[168:169], v[120:121]
    v_pk_mul_f32 v[138:139], v[170:171], v[122:123]
    v_pk_mul_f32 v[140:141], v[172:173], v[124:125]
    v_pk_mul_f32 v[142:143], v[174:175], v[126:127]
    v_cvt_pk_bf16_f32 v96, v136, v137
    v_cvt_pk_bf16_f32 v97, v138, v139
    v_cvt_pk_bf16_f32 v98, v140, v141
    v_cvt_pk_bf16_f32 v99, v142, v143
    v_mfma_f32_16x16x32_bf16 v[192:195], v[232:235], v[208:211], 0
    v_mfma_f32_16x16x32_bf16 v[204:207], v[236:239], v[212:215], 0
    v_mfma_f32_16x16x32_bf16 v[196:199], v[232:235], v[96:99], 0
    s_mov_b32 exec_lo, 0x00100001
    s_mov_b32 exec_hi, 0x10000100
    s_nop 3
    v_add_f32 v80, v80, v192
    v_add_f32 v92, v92, v204
    v_add_f32 v84, v84, v196
    s_mov_b32 exec_lo, 0x00200002
    s_mov_b32 exec_hi, 0x20000200
    v_add_f32 v81, v81, v193
    v_add_f32 v93, v93, v205
    v_add_f32 v85, v85, v197
    s_mov_b32 exec_lo, 0x00400004
    s_mov_b32 exec_hi, 0x40000400
    v_add_f32 v82, v82, v194
    v_add_f32 v94, v94, v206
    v_add_f32 v86, v86, v198
    s_mov_b32 exec_lo, 0x00800008
    s_mov_b32 exec_hi, 0x80000800
    v_add_f32 v83, v83, v195
    v_add_f32 v95, v95, v207
    v_add_f32 v87, v87, v199
    s_mov_b64 exec, -1
    v_mov_b32 v16, v112
    v_mov_b32 v176, v120
    v_mov_b32 v184, 1.0
    v_mov_b32 v17, v113
    v_mov_b32 v177, v121
    v_mov_b32 v185, 1.0
    v_mov_b32 v18, v114
    v_mov_b32 v178, v122
    v_mov_b32 v186, 1.0
    v_mov_b32 v19, v115
    v_mov_b32 v179, v123
    v_mov_b32 v187, 1.0
    v_mov_b32 v20, v116
    v_mov_b32 v180, v124
    v_mov_b32 v188, 1.0
    v_mov_b32 v21, v117
    v_mov_b32 v181, v125
    v_mov_b32 v189, 1.0
    v_mov_b32 v22, v118
    v_mov_b32 v182, v126
    v_mov_b32 v190, 1.0
    v_mov_b32 v23, v119
    v_mov_b32 v183, v127
    v_mov_b32 v191, 1.0
    v_pk_mul_f32 v[24:25], v[112:113], v[120:121]
    v_pk_mul_f32 v[26:27], v[114:115], v[122:123]
    v_pk_mul_f32 v[28:29], v[116:117], v[124:125]
    v_pk_mul_f32 v[30:31], v[118:119], v[126:127]
    v_pk_mul_f32 v[128:129], v[112:113], v[120:121]
    v_pk_mul_f32 v[130:131], v[114:115], v[122:123]
    v_pk_mul_f32 v[132:133], v[116:117], v[124:125]
    v_pk_mul_f32 v[134:135], v[118:119], v[126:127]
    v_pk_mul_f32 v[224:225], v[160:161], v[16:17]
    v_pk_mul_f32 v[226:227], v[162:163], v[18:19]
    v_pk_mul_f32 v[228:229], v[164:165], v[20:21]
    v_pk_mul_f32 v[230:231], v[166:167], v[22:23]
    v_pk_mul_f32 v[232:233], v[168:169], v[24:25]
    v_pk_mul_f32 v[234:235], v[170:171], v[26:27]
    v_pk_mul_f32 v[236:237], v[172:173], v[28:29]
    v_pk_mul_f32 v[238:239], v[174:175], v[30:31]
    v_cvt_pk_bf16_f32 v208, v224, v225
    v_cvt_pk_bf16_f32 v209, v226, v227
    v_cvt_pk_bf16_f32 v210, v228, v229
    v_cvt_pk_bf16_f32 v211, v230, v231
    v_cvt_pk_bf16_f32 v212, v232, v233
    v_cvt_pk_bf16_f32 v213, v234, v235
    v_cvt_pk_bf16_f32 v214, v236, v237
    v_cvt_pk_bf16_f32 v215, v238, v239
    v_pk_mul_f32 v[224:225], v[144:145], v[176:177]
    v_pk_mul_f32 v[226:227], v[146:147], v[178:179]
    v_pk_mul_f32 v[228:229], v[148:149], v[180:181]
    v_pk_mul_f32 v[230:231], v[150:151], v[182:183]
    v_pk_mul_f32 v[232:233], v[152:153], v[184:185]
    v_pk_mul_f32 v[234:235], v[154:155], v[186:187]
    v_pk_mul_f32 v[236:237], v[156:157], v[188:189]
    v_pk_mul_f32 v[238:239], v[158:159], v[190:191]
    v_cvt_pk_bf16_f32 v96, v224, v225
    v_cvt_pk_bf16_f32 v97, v226, v227
    v_cvt_pk_bf16_f32 v98, v228, v229
    v_cvt_pk_bf16_f32 v99, v230, v231
    v_cvt_pk_bf16_f32 v100, v232, v233
    v_cvt_pk_bf16_f32 v101, v234, v235
    v_cvt_pk_bf16_f32 v102, v236, v237
    v_cvt_pk_bf16_f32 v103, v238, v239
    v_mfma_f32_16x16x32_bf16 v[192:195], v[96:99], v[208:211], 0
    v_mfma_f32_16x16x32_bf16 v[196:199], v[96:99], v[212:215], 0
    v_mfma_f32_16x16x32_bf16 v[200:203], v[100:103], v[208:211], 0
    v_mfma_f32_16x16x32_bf16 v[204:207], v[100:103], v[212:215], 0
    s_mov_b32 exec_lo, 0x00200002
    s_mov_b32 exec_hi, 0x20000200
    s_nop 2
    v_add_f32 v80, v80, v192
    v_add_f32 v84, v84, v196
    v_add_f32 v88, v88, v200
    v_add_f32 v92, v92, v204
    s_mov_b32 exec_lo, 0x00000000
    s_mov_b32 exec_hi, 0x00000000
    v_add_f32 v81, v81, v193
    v_add_f32 v85, v85, v197
    v_add_f32 v89, v89, v201
    v_add_f32 v93, v93, v205
    s_mov_b32 exec_lo, 0x00800008
    s_mov_b32 exec_hi, 0x80000800
    v_add_f32 v82, v82, v194
    v_add_f32 v86, v86, v198
    v_add_f32 v90, v90, v202
    v_add_f32 v94, v94, v206
    s_mov_b32 exec_lo, 0x00000000
    s_mov_b32 exec_hi, 0x00000000
    v_add_f32 v83, v83, v195
    v_add_f32 v87, v87, v199
    v_add_f32 v91, v91, v203
    v_add_f32 v95, v95, v207
    s_mov_b64 exec, -1
    v_mov_b32_dpp v136, v128 quad_perm:[1,0,3,2] row_mask:0xf bank_mask:0xf
    v_mov_b32_dpp v137, v129 quad_perm:[1,0,3,2] row_mask:0xf bank_mask:0xf
    v_mov_b32_dpp v138, v130 quad_perm:[1,0,3,2] row_mask:0xf bank_mask:0xf
    v_mov_b32_dpp v139, v131 quad_perm:[1,0,3,2] row_mask:0xf bank_mask:0xf
    v_mov_b32_dpp v140, v132 quad_perm:[1,0,3,2] row_mask:0xf bank_mask:0xf
    v_mov_b32_dpp v141, v133 quad_perm:[1,0,3,2] row_mask:0xf bank_mask:0xf
    v_mov_b32_dpp v142, v134 quad_perm:[1,0,3,2] row_mask:0xf bank_mask:0xf
    v_mov_b32_dpp v143, v135 quad_perm:[1,0,3,2] row_mask:0xf bank_mask:0xf
    s_mov_b32 exec_lo, 0xaaaaaaaa
    s_mov_b32 exec_hi, 0xaaaaaaaa
    v_pk_mul_f32 v[16:17], v[16:17], v[136:137]
    v_pk_mul_f32 v[18:19], v[18:19], v[138:139]
    v_pk_mul_f32 v[20:21], v[20:21], v[140:141]
    v_pk_mul_f32 v[22:23], v[22:23], v[142:143]
    v_pk_mul_f32 v[24:25], v[24:25], v[136:137]
    v_pk_mul_f32 v[26:27], v[26:27], v[138:139]
    v_pk_mul_f32 v[28:29], v[28:29], v[140:141]
    v_pk_mul_f32 v[30:31], v[30:31], v[142:143]
    s_mov_b32 exec_lo, 0x55555555
    s_mov_b32 exec_hi, 0x55555555
    v_pk_mul_f32 v[176:177], v[176:177], v[136:137]
    v_pk_mul_f32 v[178:179], v[178:179], v[138:139]
    v_pk_mul_f32 v[180:181], v[180:181], v[140:141]
    v_pk_mul_f32 v[182:183], v[182:183], v[142:143]
    v_pk_mul_f32 v[184:185], v[184:185], v[136:137]
    v_pk_mul_f32 v[186:187], v[186:187], v[138:139]
    v_pk_mul_f32 v[188:189], v[188:189], v[140:141]
    v_pk_mul_f32 v[190:191], v[190:191], v[142:143]
    s_mov_b64 exec, -1
    v_pk_mul_f32 v[128:129], v[128:129], v[136:137]
    v_pk_mul_f32 v[130:131], v[130:131], v[138:139]
    v_pk_mul_f32 v[132:133], v[132:133], v[140:141]
    v_pk_mul_f32 v[134:135], v[134:135], v[142:143]
    v_pk_mul_f32 v[224:225], v[160:161], v[16:17]
    v_pk_mul_f32 v[226:227], v[162:163], v[18:19]
    v_pk_mul_f32 v[228:229], v[164:165], v[20:21]
    v_pk_mul_f32 v[230:231], v[166:167], v[22:23]
    v_pk_mul_f32 v[232:233], v[168:169], v[24:25]
    v_pk_mul_f32 v[234:235], v[170:171], v[26:27]
    v_pk_mul_f32 v[236:237], v[172:173], v[28:29]
    v_pk_mul_f32 v[238:239], v[174:175], v[30:31]
    v_cvt_pk_bf16_f32 v208, v224, v225
    v_cvt_pk_bf16_f32 v209, v226, v227
    v_cvt_pk_bf16_f32 v210, v228, v229
    v_cvt_pk_bf16_f32 v211, v230, v231
    v_cvt_pk_bf16_f32 v212, v232, v233
    v_cvt_pk_bf16_f32 v213, v234, v235
    v_cvt_pk_bf16_f32 v214, v236, v237
    v_cvt_pk_bf16_f32 v215, v238, v239
    v_pk_mul_f32 v[224:225], v[144:145], v[176:177]
    v_pk_mul_f32 v[226:227], v[146:147], v[178:179]
    v_pk_mul_f32 v[228:229], v[148:149], v[180:181]
    v_pk_mul_f32 v[230:231], v[150:151], v[182:183]
    v_pk_mul_f32 v[232:233], v[152:153], v[184:185]
    v_pk_mul_f32 v[234:235], v[154:155], v[186:187]
    v_pk_mul_f32 v[236:237], v[156:157], v[188:189]
    v_pk_mul_f32 v[238:239], v[158:159], v[190:191]
    v_cvt_pk_bf16_f32 v96, v224, v225
    v_cvt_pk_bf16_f32 v97, v226, v227
    v_cvt_pk_bf16_f32 v98, v228, v229
    v_cvt_pk_bf16_f32 v99, v230, v231
    v_cvt_pk_bf16_f32 v100, v232, v233
    v_cvt_pk_bf16_f32 v101, v234, v235
    v_cvt_pk_bf16_f32 v102, v236, v237
    v_cvt_pk_bf16_f32 v103, v238, v239
    v_mfma_f32_16x16x32_bf16 v[192:195], v[96:99], v[208:211], 0
    v_mfma_f32_16x16x32_bf16 v[196:199], v[96:99], v[212:215], 0
    v_mfma_f32_16x16x32_bf16 v[200:203], v[100:103], v[208:211], 0
    v_mfma_f32_16x16x32_bf16 v[204:207], v[100:103], v[212:215], 0
    s_mov_b32 exec_lo, 0x00c0000c
    s_mov_b32 exec_hi, 0xc0000c00
    s_nop 2
    v_add_f32 v80, v80, v192
    v_add_f32 v84, v84, v196
    v_add_f32 v88, v88, v200
    v_add_f32 v92, v92, v204
    s_mov_b32 exec_lo, 0x00c0000c
    s_mov_b32 exec_hi, 0xc0000c00
    v_add_f32 v81, v81, v193
    v_add_f32 v85, v85, v197
    v_add_f32 v89, v89, v201
    v_add_f32 v93, v93, v205
    s_mov_b32 exec_lo, 0x00000000
    s_mov_b32 exec_hi, 0x00000000
    v_add_f32 v82, v82, v194
    v_add_f32 v86, v86, v198
    v_add_f32 v90, v90, v202
    v_add_f32 v94, v94, v206
    s_mov_b32 exec_lo, 0x00000000
    s_mov_b32 exec_hi, 0x00000000
    v_add_f32 v83, v83, v195
    v_add_f32 v87, v87, v199
    v_add_f32 v91, v91, v203
    v_add_f32 v95, v95, v207
    s_mov_b64 exec, -1
    v_mov_b32_dpp v136, v128 quad_perm:[2,3,0,1] row_mask:0xf bank_mask:0xf
    v_mov_b32_dpp v137, v129 quad_perm:[2,3,0,1] row_mask:0xf bank_mask:0xf
    v_mov_b32_dpp v138, v130 quad_perm:[2,3,0,1] row_mask:0xf bank_mask:0xf
    v_mov_b32_dpp v139, v131 quad_perm:[2,3,0,1] row_mask:0xf bank_mask:0xf
    v_mov_b32_dpp v140, v132 quad_perm:[2,3,0,1] row_mask:0xf bank_mask:0xf
    v_mov_b32_dpp v141, v133 quad_perm:[2,3,0,1] row_mask:0xf bank_mask:0xf
    v_mov_b32_dpp v142, v134 quad_perm:[2,3,0,1] row_mask:0xf bank_mask:0xf
    v_mov_b32_dpp v143, v135 quad_perm:[2,3,0,1] row_mask:0xf bank_mask:0xf
    s_mov_b32 exec_lo, 0xcccccccc
    s_mov_b32 exec_hi, 0xcccccccc
    v_pk_mul_f32 v[16:17], v[16:17], v[136:137]
    v_pk_mul_f32 v[18:19], v[18:19], v[138:139]
    v_pk_mul_f32 v[20:21], v[20:21], v[140:141]
    v_pk_mul_f32 v[22:23], v[22:23], v[142:143]
    v_pk_mul_f32 v[24:25], v[24:25], v[136:137]
    v_pk_mul_f32 v[26:27], v[26:27], v[138:139]
    v_pk_mul_f32 v[28:29], v[28:29], v[140:141]
    v_pk_mul_f32 v[30:31], v[30:31], v[142:143]
    s_mov_b32 exec_lo, 0x33333333
    s_mov_b32 exec_hi, 0x33333333
    v_pk_mul_f32 v[176:177], v[176:177], v[136:137]
    v_pk_mul_f32 v[178:179], v[178:179], v[138:139]
    v_pk_mul_f32 v[180:181], v[180:181], v[140:141]
    v_pk_mul_f32 v[182:183], v[182:183], v[142:143]
    v_pk_mul_f32 v[184:185], v[184:185], v[136:137]
    v_pk_mul_f32 v[186:187], v[186:187], v[138:139]
    v_pk_mul_f32 v[188:189], v[188:189], v[140:141]
    v_pk_mul_f32 v[190:191], v[190:191], v[142:143]
    s_mov_b64 exec, -1
    v_pk_mul_f32 v[128:129], v[128:129], v[136:137]
    v_pk_mul_f32 v[130:131], v[130:131], v[138:139]
    v_pk_mul_f32 v[132:133], v[132:133], v[140:141]
    v_pk_mul_f32 v[134:135], v[134:135], v[142:143]
    v_pk_mul_f32 v[224:225], v[160:161], v[16:17]
    v_pk_mul_f32 v[226:227], v[162:163], v[18:19]
    v_pk_mul_f32 v[228:229], v[164:165], v[20:21]
    v_pk_mul_f32 v[230:231], v[166:167], v[22:23]
    v_pk_mul_f32 v[232:233], v[168:169], v[24:25]
    v_pk_mul_f32 v[234:235], v[170:171], v[26:27]
    v_pk_mul_f32 v[236:237], v[172:173], v[28:29]
    v_pk_mul_f32 v[238:239], v[174:175], v[30:31]
    v_cvt_pk_bf16_f32 v208, v224, v225
    v_cvt_pk_bf16_f32 v209, v226, v227
    v_cvt_pk_bf16_f32 v210, v228, v229
    v_cvt_pk_bf16_f32 v211, v230, v231
    v_cvt_pk_bf16_f32 v212, v232, v233
    v_cvt_pk_bf16_f32 v213, v234, v235
    v_cvt_pk_bf16_f32 v214, v236, v237
    v_cvt_pk_bf16_f32 v215, v238, v239
    v_pk_mul_f32 v[224:225], v[144:145], v[176:177]
    v_pk_mul_f32 v[226:227], v[146:147], v[178:179]
    v_pk_mul_f32 v[228:229], v[148:149], v[180:181]
    v_pk_mul_f32 v[230:231], v[150:151], v[182:183]
    v_pk_mul_f32 v[232:233], v[152:153], v[184:185]
    v_pk_mul_f32 v[234:235], v[154:155], v[186:187]
    v_pk_mul_f32 v[236:237], v[156:157], v[188:189]
    v_pk_mul_f32 v[238:239], v[158:159], v[190:191]
    v_cvt_pk_bf16_f32 v96, v224, v225
    v_cvt_pk_bf16_f32 v97, v226, v227
    v_cvt_pk_bf16_f32 v98, v228, v229
    v_cvt_pk_bf16_f32 v99, v230, v231
    v_cvt_pk_bf16_f32 v100, v232, v233
    v_cvt_pk_bf16_f32 v101, v234, v235
    v_cvt_pk_bf16_f32 v102, v236, v237
    v_cvt_pk_bf16_f32 v103, v238, v239
    v_mfma_f32_16x16x32_bf16 v[192:195], v[96:99], v[208:211], 0
    v_mfma_f32_16x16x32_bf16 v[196:199], v[96:99], v[212:215], 0
    v_mfma_f32_16x16x32_bf16 v[200:203], v[100:103], v[208:211], 0
    v_mfma_f32_16x16x32_bf16 v[204:207], v[100:103], v[212:215], 0
    s_mov_b32 exec_lo, 0x000000f0
    s_mov_b32 exec_hi, 0x0000f000
    s_nop 2
    v_add_f32 v80, v80, v192
    v_add_f32 v84, v84, v196
    v_add_f32 v88, v88, v200
    v_add_f32 v92, v92, v204
    s_mov_b32 exec_lo, 0x000000f0
    s_mov_b32 exec_hi, 0x0000f000
    v_add_f32 v81, v81, v193
    v_add_f32 v85, v85, v197
    v_add_f32 v89, v89, v201
    v_add_f32 v93, v93, v205
    s_mov_b32 exec_lo, 0x000000f0
    s_mov_b32 exec_hi, 0x0000f000
    v_add_f32 v82, v82, v194
    v_add_f32 v86, v86, v198
    v_add_f32 v90, v90, v202
    v_add_f32 v94, v94, v206
    s_mov_b32 exec_lo, 0x000000f0
    s_mov_b32 exec_hi, 0x0000f000
    v_add_f32 v83, v83, v195
    v_add_f32 v87, v87, v199
    v_add_f32 v91, v91, v203
    v_add_f32 v95, v95, v207
    s_mov_b64 exec, -1
    v_mov_b32_dpp v136, v128 row_half_mirror row_mask:0xf bank_mask:0xf
    v_mov_b32_dpp v137, v129 row_half_mirror row_mask:0xf bank_mask:0xf
    v_mov_b32_dpp v138, v130 row_half_mirror row_mask:0xf bank_mask:0xf
    v_mov_b32_dpp v139, v131 row_half_mirror row_mask:0xf bank_mask:0xf
    v_mov_b32_dpp v140, v132 row_half_mirror row_mask:0xf bank_mask:0xf
    v_mov_b32_dpp v141, v133 row_half_mirror row_mask:0xf bank_mask:0xf
    v_mov_b32_dpp v142, v134 row_half_mirror row_mask:0xf bank_mask:0xf
    v_mov_b32_dpp v143, v135 row_half_mirror row_mask:0xf bank_mask:0xf
    s_mov_b32 exec_lo, 0xf0f0f0f0
    s_mov_b32 exec_hi, 0xf0f0f0f0
    v_pk_mul_f32 v[16:17], v[16:17], v[136:137]
    v_pk_mul_f32 v[18:19], v[18:19], v[138:139]
    v_pk_mul_f32 v[20:21], v[20:21], v[140:141]
    v_pk_mul_f32 v[22:23], v[22:23], v[142:143]
    v_pk_mul_f32 v[24:25], v[24:25], v[136:137]
    v_pk_mul_f32 v[26:27], v[26:27], v[138:139]
    v_pk_mul_f32 v[28:29], v[28:29], v[140:141]
    v_pk_mul_f32 v[30:31], v[30:31], v[142:143]
    s_mov_b32 exec_lo, 0x0f0f0f0f
    s_mov_b32 exec_hi, 0x0f0f0f0f
    v_pk_mul_f32 v[176:177], v[176:177], v[136:137]
    v_pk_mul_f32 v[178:179], v[178:179], v[138:139]
    v_pk_mul_f32 v[180:181], v[180:181], v[140:141]
    v_pk_mul_f32 v[182:183], v[182:183], v[142:143]
    v_pk_mul_f32 v[184:185], v[184:185], v[136:137]
    v_pk_mul_f32 v[186:187], v[186:187], v[138:139]
    v_pk_mul_f32 v[188:189], v[188:189], v[140:141]
    v_pk_mul_f32 v[190:191], v[190:191], v[142:143]
    s_mov_b64 exec, -1
    v_pk_mul_f32 v[128:129], v[128:129], v[136:137]
    v_pk_mul_f32 v[130:131], v[130:131], v[138:139]
    v_pk_mul_f32 v[132:133], v[132:133], v[140:141]
    v_pk_mul_f32 v[134:135], v[134:135], v[142:143]
    v_pk_mul_f32 v[224:225], v[160:161], v[16:17]
    v_pk_mul_f32 v[226:227], v[162:163], v[18:19]
    v_pk_mul_f32 v[228:229], v[164:165], v[20:21]
    v_pk_mul_f32 v[230:231], v[166:167], v[22:23]
    v_pk_mul_f32 v[232:233], v[168:169], v[24:25]
    v_pk_mul_f32 v[234:235], v[170:171], v[26:27]
    v_pk_mul_f32 v[236:237], v[172:173], v[28:29]
    v_pk_mul_f32 v[238:239], v[174:175], v[30:31]
    v_cvt_pk_bf16_f32 v208, v224, v225
    v_cvt_pk_bf16_f32 v209, v226, v227
    v_cvt_pk_bf16_f32 v210, v228, v229
    v_cvt_pk_bf16_f32 v211, v230, v231
    v_cvt_pk_bf16_f32 v212, v232, v233
    v_cvt_pk_bf16_f32 v213, v234, v235
    v_cvt_pk_bf16_f32 v214, v236, v237
    v_cvt_pk_bf16_f32 v215, v238, v239
    v_pk_mul_f32 v[224:225], v[144:145], v[176:177]
    v_pk_mul_f32 v[226:227], v[146:147], v[178:179]
    v_pk_mul_f32 v[228:229], v[148:149], v[180:181]
    v_pk_mul_f32 v[230:231], v[150:151], v[182:183]
    v_pk_mul_f32 v[232:233], v[152:153], v[184:185]
    v_pk_mul_f32 v[234:235], v[154:155], v[186:187]
    v_pk_mul_f32 v[236:237], v[156:157], v[188:189]
    v_pk_mul_f32 v[238:239], v[158:159], v[190:191]
    v_cvt_pk_bf16_f32 v96, v224, v225
    v_cvt_pk_bf16_f32 v97, v226, v227
    v_cvt_pk_bf16_f32 v98, v228, v229
    v_cvt_pk_bf16_f32 v99, v230, v231
    v_cvt_pk_bf16_f32 v100, v232, v233
    v_cvt_pk_bf16_f32 v101, v234, v235
    v_cvt_pk_bf16_f32 v102, v236, v237
    v_cvt_pk_bf16_f32 v103, v238, v239
    v_mfma_f32_16x16x32_bf16 v[192:195], v[96:99], v[208:211], 0
    v_mfma_f32_16x16x32_bf16 v[196:199], v[96:99], v[212:215], 0
    v_mfma_f32_16x16x32_bf16 v[200:203], v[100:103], v[208:211], 0
    v_mfma_f32_16x16x32_bf16 v[204:207], v[100:103], v[212:215], 0
    s_mov_b32 exec_lo, 0xff00ff00
    s_mov_b32 exec_hi, 0x00000000
    s_nop 2
    v_add_f32 v80, v80, v192
    v_add_f32 v84, v84, v196
    v_add_f32 v88, v88, v200
    v_add_f32 v92, v92, v204
    s_mov_b32 exec_lo, 0xff00ff00
    s_mov_b32 exec_hi, 0x00000000
    v_add_f32 v81, v81, v193
    v_add_f32 v85, v85, v197
    v_add_f32 v89, v89, v201
    v_add_f32 v93, v93, v205
    s_mov_b32 exec_lo, 0xff00ff00
    s_mov_b32 exec_hi, 0x00000000
    v_add_f32 v82, v82, v194
    v_add_f32 v86, v86, v198
    v_add_f32 v90, v90, v202
    v_add_f32 v94, v94, v206
    s_mov_b32 exec_lo, 0xff00ff00
    s_mov_b32 exec_hi, 0x00000000
    v_add_f32 v83, v83, v195
    v_add_f32 v87, v87, v199
    v_add_f32 v91, v91, v203
    v_add_f32 v95, v95, v207
    s_mov_b64 exec, -1
    v_mov_b32_dpp v136, v128 row_mirror row_mask:0xf bank_mask:0xf
    v_mov_b32_dpp v137, v129 row_mirror row_mask:0xf bank_mask:0xf
    v_mov_b32_dpp v138, v130 row_mirror row_mask:0xf bank_mask:0xf
    v_mov_b32_dpp v139, v131 row_mirror row_mask:0xf bank_mask:0xf
    v_mov_b32_dpp v140, v132 row_mirror row_mask:0xf bank_mask:0xf
    v_mov_b32_dpp v141, v133 row_mirror row_mask:0xf bank_mask:0xf
    v_mov_b32_dpp v142, v134 row_mirror row_mask:0xf bank_mask:0xf
    v_mov_b32_dpp v143, v135 row_mirror row_mask:0xf bank_mask:0xf
    s_mov_b32 exec_lo, 0xff00ff00
    s_mov_b32 exec_hi, 0xff00ff00
    v_pk_mul_f32 v[16:17], v[16:17], v[136:137]
    v_pk_mul_f32 v[18:19], v[18:19], v[138:139]
    v_pk_mul_f32 v[20:21], v[20:21], v[140:141]
    v_pk_mul_f32 v[22:23], v[22:23], v[142:143]
    v_pk_mul_f32 v[24:25], v[24:25], v[136:137]
    v_pk_mul_f32 v[26:27], v[26:27], v[138:139]
    v_pk_mul_f32 v[28:29], v[28:29], v[140:141]
    v_pk_mul_f32 v[30:31], v[30:31], v[142:143]
    s_mov_b32 exec_lo, 0x00ff00ff
    s_mov_b32 exec_hi, 0x00ff00ff
    v_pk_mul_f32 v[176:177], v[176:177], v[136:137]
    v_pk_mul_f32 v[178:179], v[178:179], v[138:139]
    v_pk_mul_f32 v[180:181], v[180:181], v[140:141]
    v_pk_mul_f32 v[182:183], v[182:183], v[142:143]
    v_pk_mul_f32 v[184:185], v[184:185], v[136:137]
    v_pk_mul_f32 v[186:187], v[186:187], v[138:139]
    v_pk_mul_f32 v[188:189], v[188:189], v[140:141]
    v_pk_mul_f32 v[190:191], v[190:191], v[142:143]
    s_mov_b64 exec, -1
    v_pk_mul_f32 v[128:129], v[128:129], v[136:137]
    v_pk_mul_f32 v[130:131], v[130:131], v[138:139]
    v_pk_mul_f32 v[132:133], v[132:133], v[140:141]
    v_pk_mul_f32 v[134:135], v[134:135], v[142:143]
    v_pk_mul_f32 v[224:225], v[144:145], v[176:177]
    v_pk_mul_f32 v[226:227], v[146:147], v[178:179]
    v_pk_mul_f32 v[228:229], v[148:149], v[180:181]
    v_pk_mul_f32 v[230:231], v[150:151], v[182:183]
    v_pk_mul_f32 v[232:233], v[152:153], v[184:185]
    v_pk_mul_f32 v[234:235], v[154:155], v[186:187]
    v_pk_mul_f32 v[236:237], v[156:157], v[188:189]
    v_pk_mul_f32 v[238:239], v[158:159], v[190:191]
    v_cvt_pk_bf16_f32 v96, v224, v225
    v_cvt_pk_bf16_f32 v97, v226, v227
    v_cvt_pk_bf16_f32 v98, v228, v229
    v_cvt_pk_bf16_f32 v99, v230, v231
    v_cvt_pk_bf16_f32 v100, v232, v233
    v_cvt_pk_bf16_f32 v101, v234, v235
    v_cvt_pk_bf16_f32 v102, v236, v237
    v_cvt_pk_bf16_f32 v103, v238, v239
    ds_write_b64 v8, v[96:97] offset:0
    ds_write_b64 v9, v[98:99] offset:0
    ds_write_b64 v9, v[100:101] offset:256
    ds_write_b64 v8, v[102:103] offset:256
    s_mov_b32 exec_lo, 0x80008000
    s_mov_b32 exec_hi, 0x80008000
    ds_write_b128 v5, v[24:27] offset:0
    ds_write_b128 v5, v[28:31] offset:16
    s_mov_b64 exec, -1
    buffer_load_dwordx4 v[224:227], v104, s[44:47], s6 offen offset:64
    buffer_load_dwordx4 v[228:231], v104, s[44:47], s6 offen offset:320
    buffer_load_dwordx4 v[232:235], v104, s[36:39], s6 offen offset:64
    buffer_load_dwordx4 v[236:239], v104, s[36:39], s6 offen offset:320
    buffer_load_dwordx4 v[208:211], v104, s[32:35], s6 offen offset:64
    buffer_load_dwordx4 v[212:215], v104, s[32:35], s6 offen offset:320
    s_waitcnt vmcnt(0)
    v_lshlrev_b32 v112, 16, v224
    v_and_b32 v113, 0xffff0000, v224
    v_lshlrev_b32 v114, 16, v225
    v_and_b32 v115, 0xffff0000, v225
    v_lshlrev_b32 v116, 16, v226
    v_and_b32 v117, 0xffff0000, v226
    v_lshlrev_b32 v118, 16, v227
    v_and_b32 v119, 0xffff0000, v227
    v_lshlrev_b32 v120, 16, v228
    v_and_b32 v121, 0xffff0000, v228
    v_lshlrev_b32 v122, 16, v229
    v_and_b32 v123, 0xffff0000, v229
    v_lshlrev_b32 v124, 16, v230
    v_and_b32 v125, 0xffff0000, v230
    v_lshlrev_b32 v126, 16, v231
    v_and_b32 v127, 0xffff0000, v231
    v_lshlrev_b32 v144, 16, v232
    v_and_b32 v145, 0xffff0000, v232
    v_lshlrev_b32 v146, 16, v233
    v_and_b32 v147, 0xffff0000, v233
    v_lshlrev_b32 v148, 16, v234
    v_and_b32 v149, 0xffff0000, v234
    v_lshlrev_b32 v150, 16, v235
    v_and_b32 v151, 0xffff0000, v235
    v_lshlrev_b32 v152, 16, v236
    v_and_b32 v153, 0xffff0000, v236
    v_lshlrev_b32 v154, 16, v237
    v_and_b32 v155, 0xffff0000, v237
    v_lshlrev_b32 v156, 16, v238
    v_and_b32 v157, 0xffff0000, v238
    v_lshlrev_b32 v158, 16, v239
    v_and_b32 v159, 0xffff0000, v239
    v_lshlrev_b32 v160, 16, v208
    v_and_b32 v161, 0xffff0000, v208
    v_lshlrev_b32 v162, 16, v209
    v_and_b32 v163, 0xffff0000, v209
    v_lshlrev_b32 v164, 16, v210
    v_and_b32 v165, 0xffff0000, v210
    v_lshlrev_b32 v166, 16, v211
    v_and_b32 v167, 0xffff0000, v211
    v_lshlrev_b32 v168, 16, v212
    v_and_b32 v169, 0xffff0000, v212
    v_lshlrev_b32 v170, 16, v213
    v_and_b32 v171, 0xffff0000, v213
    v_lshlrev_b32 v172, 16, v214
    v_and_b32 v173, 0xffff0000, v214
    v_lshlrev_b32 v174, 16, v215
    v_and_b32 v175, 0xffff0000, v215
    v_pk_mul_f32 v[144:145], v[144:145], s[12:13]
    v_pk_mul_f32 v[146:147], v[146:147], s[12:13]
    v_pk_mul_f32 v[148:149], v[148:149], s[12:13]
    v_pk_mul_f32 v[150:151], v[150:151], s[12:13]
    v_pk_mul_f32 v[152:153], v[152:153], s[12:13]
    v_pk_mul_f32 v[154:155], v[154:155], s[12:13]
    v_pk_mul_f32 v[156:157], v[156:157], s[12:13]
    v_pk_mul_f32 v[158:159], v[158:159], s[12:13]
    v_cvt_pk_bf16_f32 v232, v144, v145
    v_cvt_pk_bf16_f32 v233, v146, v147
    v_cvt_pk_bf16_f32 v234, v148, v149
    v_cvt_pk_bf16_f32 v235, v150, v151
    v_cvt_pk_bf16_f32 v236, v152, v153
    v_cvt_pk_bf16_f32 v237, v154, v155
    v_cvt_pk_bf16_f32 v238, v156, v157
    v_cvt_pk_bf16_f32 v239, v158, v159
    v_pk_mul_f32 v[112:113], v[112:113], s[8:9]
    v_pk_mul_f32 v[114:115], v[114:115], s[8:9]
    v_pk_mul_f32 v[116:117], v[116:117], s[8:9]
    v_pk_mul_f32 v[118:119], v[118:119], s[8:9]
    v_pk_mul_f32 v[120:121], v[120:121], s[8:9]
    v_pk_mul_f32 v[122:123], v[122:123], s[8:9]
    v_pk_mul_f32 v[124:125], v[124:125], s[8:9]
    v_pk_mul_f32 v[126:127], v[126:127], s[8:9]
    v_exp_f32 v112, v112
    v_exp_f32 v113, v113
    v_exp_f32 v114, v114
    v_exp_f32 v115, v115
    v_exp_f32 v116, v116
    v_exp_f32 v117, v117
    v_exp_f32 v118, v118
    v_exp_f32 v119, v119
    v_exp_f32 v120, v120
    v_exp_f32 v121, v121
    v_exp_f32 v122, v122
    v_exp_f32 v123, v123
    v_exp_f32 v124, v124
    v_exp_f32 v125, v125
    v_exp_f32 v126, v126
    v_exp_f32 v127, v127
    v_pk_add_f32 v[112:113], v[112:113], s[10:11]
    v_pk_add_f32 v[114:115], v[114:115], s[10:11]
    v_pk_add_f32 v[116:117], v[116:117], s[10:11]
    v_pk_add_f32 v[118:119], v[118:119], s[10:11]
    v_pk_add_f32 v[120:121], v[120:121], s[10:11]
    v_pk_add_f32 v[122:123], v[122:123], s[10:11]
    v_pk_add_f32 v[124:125], v[124:125], s[10:11]
    v_pk_add_f32 v[126:127], v[126:127], s[10:11]
    v_rcp_f32 v112, v112
    v_rcp_f32 v113, v113
    v_rcp_f32 v114, v114
    v_rcp_f32 v115, v115
    v_rcp_f32 v116, v116
    v_rcp_f32 v117, v117
    v_rcp_f32 v118, v118
    v_rcp_f32 v119, v119
    v_rcp_f32 v120, v120
    v_rcp_f32 v121, v121
    v_rcp_f32 v122, v122
    v_rcp_f32 v123, v123
    v_rcp_f32 v124, v124
    v_rcp_f32 v125, v125
    v_rcp_f32 v126, v126
    v_rcp_f32 v127, v127
    v_pk_mul_f32 v[136:137], v[168:169], v[120:121]
    v_pk_mul_f32 v[138:139], v[170:171], v[122:123]
    v_pk_mul_f32 v[140:141], v[172:173], v[124:125]
    v_pk_mul_f32 v[142:143], v[174:175], v[126:127]
    v_cvt_pk_bf16_f32 v96, v136, v137
    v_cvt_pk_bf16_f32 v97, v138, v139
    v_cvt_pk_bf16_f32 v98, v140, v141
    v_cvt_pk_bf16_f32 v99, v142, v143
    v_mfma_f32_16x16x32_bf16 v[192:195], v[232:235], v[208:211], 0
    v_mfma_f32_16x16x32_bf16 v[204:207], v[236:239], v[212:215], 0
    v_mfma_f32_16x16x32_bf16 v[196:199], v[232:235], v[96:99], 0
    s_mov_b32 exec_lo, 0x00100001
    s_mov_b32 exec_hi, 0x10000100
    s_nop 3
    v_add_f32 v80, v80, v192
    v_add_f32 v92, v92, v204
    v_add_f32 v84, v84, v196
    s_mov_b32 exec_lo, 0x00200002
    s_mov_b32 exec_hi, 0x20000200
    v_add_f32 v81, v81, v193
    v_add_f32 v93, v93, v205
    v_add_f32 v85, v85, v197
    s_mov_b32 exec_lo, 0x00400004
    s_mov_b32 exec_hi, 0x40000400
    v_add_f32 v82, v82, v194
    v_add_f32 v94, v94, v206
    v_add_f32 v86, v86, v198
    s_mov_b32 exec_lo, 0x00800008
    s_mov_b32 exec_hi, 0x80000800
    v_add_f32 v83, v83, v195
    v_add_f32 v95, v95, v207
    v_add_f32 v87, v87, v199
    s_mov_b64 exec, -1
    v_mov_b32 v32, v112
    v_mov_b32 v176, v120
    v_mov_b32 v184, 1.0
    v_mov_b32 v33, v113
    v_mov_b32 v177, v121
    v_mov_b32 v185, 1.0
    v_mov_b32 v34, v114
    v_mov_b32 v178, v122
    v_mov_b32 v186, 1.0
    v_mov_b32 v35, v115
    v_mov_b32 v179, v123
    v_mov_b32 v187, 1.0
    v_mov_b32 v36, v116
    v_mov_b32 v180, v124
    v_mov_b32 v188, 1.0
    v_mov_b32 v37, v117
    v_mov_b32 v181, v125
    v_mov_b32 v189, 1.0
    v_mov_b32 v38, v118
    v_mov_b32 v182, v126
    v_mov_b32 v190, 1.0
    v_mov_b32 v39, v119
    v_mov_b32 v183, v127
    v_mov_b32 v191, 1.0
    v_pk_mul_f32 v[40:41], v[112:113], v[120:121]
    v_pk_mul_f32 v[42:43], v[114:115], v[122:123]
    v_pk_mul_f32 v[44:45], v[116:117], v[124:125]
    v_pk_mul_f32 v[46:47], v[118:119], v[126:127]
    v_pk_mul_f32 v[128:129], v[112:113], v[120:121]
    v_pk_mul_f32 v[130:131], v[114:115], v[122:123]
    v_pk_mul_f32 v[132:133], v[116:117], v[124:125]
    v_pk_mul_f32 v[134:135], v[118:119], v[126:127]
    v_pk_mul_f32 v[224:225], v[160:161], v[32:33]
    v_pk_mul_f32 v[226:227], v[162:163], v[34:35]
    v_pk_mul_f32 v[228:229], v[164:165], v[36:37]
    v_pk_mul_f32 v[230:231], v[166:167], v[38:39]
    v_pk_mul_f32 v[232:233], v[168:169], v[40:41]
    v_pk_mul_f32 v[234:235], v[170:171], v[42:43]
    v_pk_mul_f32 v[236:237], v[172:173], v[44:45]
    v_pk_mul_f32 v[238:239], v[174:175], v[46:47]
    v_cvt_pk_bf16_f32 v208, v224, v225
    v_cvt_pk_bf16_f32 v209, v226, v227
    v_cvt_pk_bf16_f32 v210, v228, v229
    v_cvt_pk_bf16_f32 v211, v230, v231
    v_cvt_pk_bf16_f32 v212, v232, v233
    v_cvt_pk_bf16_f32 v213, v234, v235
    v_cvt_pk_bf16_f32 v214, v236, v237
    v_cvt_pk_bf16_f32 v215, v238, v239
    v_pk_mul_f32 v[224:225], v[144:145], v[176:177]
    v_pk_mul_f32 v[226:227], v[146:147], v[178:179]
    v_pk_mul_f32 v[228:229], v[148:149], v[180:181]
    v_pk_mul_f32 v[230:231], v[150:151], v[182:183]
    v_pk_mul_f32 v[232:233], v[152:153], v[184:185]
    v_pk_mul_f32 v[234:235], v[154:155], v[186:187]
    v_pk_mul_f32 v[236:237], v[156:157], v[188:189]
    v_pk_mul_f32 v[238:239], v[158:159], v[190:191]
    v_cvt_pk_bf16_f32 v96, v224, v225
    v_cvt_pk_bf16_f32 v97, v226, v227
    v_cvt_pk_bf16_f32 v98, v228, v229
    v_cvt_pk_bf16_f32 v99, v230, v231
    v_cvt_pk_bf16_f32 v100, v232, v233
    v_cvt_pk_bf16_f32 v101, v234, v235
    v_cvt_pk_bf16_f32 v102, v236, v237
    v_cvt_pk_bf16_f32 v103, v238, v239
    v_mfma_f32_16x16x32_bf16 v[192:195], v[96:99], v[208:211], 0
    v_mfma_f32_16x16x32_bf16 v[196:199], v[96:99], v[212:215], 0
    v_mfma_f32_16x16x32_bf16 v[200:203], v[100:103], v[208:211], 0
    v_mfma_f32_16x16x32_bf16 v[204:207], v[100:103], v[212:215], 0
    s_mov_b32 exec_lo, 0x00200002
    s_mov_b32 exec_hi, 0x20000200
    s_nop 2
    v_add_f32 v80, v80, v192
    v_add_f32 v84, v84, v196
    v_add_f32 v88, v88, v200
    v_add_f32 v92, v92, v204
    s_mov_b32 exec_lo, 0x00000000
    s_mov_b32 exec_hi, 0x00000000
    v_add_f32 v81, v81, v193
    v_add_f32 v85, v85, v197
    v_add_f32 v89, v89, v201
    v_add_f32 v93, v93, v205
    s_mov_b32 exec_lo, 0x00800008
    s_mov_b32 exec_hi, 0x80000800
    v_add_f32 v82, v82, v194
    v_add_f32 v86, v86, v198
    v_add_f32 v90, v90, v202
    v_add_f32 v94, v94, v206
    s_mov_b32 exec_lo, 0x00000000
    s_mov_b32 exec_hi, 0x00000000
    v_add_f32 v83, v83, v195
    v_add_f32 v87, v87, v199
    v_add_f32 v91, v91, v203
    v_add_f32 v95, v95, v207
    s_mov_b64 exec, -1
    v_mov_b32_dpp v136, v128 quad_perm:[1,0,3,2] row_mask:0xf bank_mask:0xf
    v_mov_b32_dpp v137, v129 quad_perm:[1,0,3,2] row_mask:0xf bank_mask:0xf
    v_mov_b32_dpp v138, v130 quad_perm:[1,0,3,2] row_mask:0xf bank_mask:0xf
    v_mov_b32_dpp v139, v131 quad_perm:[1,0,3,2] row_mask:0xf bank_mask:0xf
    v_mov_b32_dpp v140, v132 quad_perm:[1,0,3,2] row_mask:0xf bank_mask:0xf
    v_mov_b32_dpp v141, v133 quad_perm:[1,0,3,2] row_mask:0xf bank_mask:0xf
    v_mov_b32_dpp v142, v134 quad_perm:[1,0,3,2] row_mask:0xf bank_mask:0xf
    v_mov_b32_dpp v143, v135 quad_perm:[1,0,3,2] row_mask:0xf bank_mask:0xf
    s_mov_b32 exec_lo, 0xaaaaaaaa
    s_mov_b32 exec_hi, 0xaaaaaaaa
    v_pk_mul_f32 v[32:33], v[32:33], v[136:137]
    v_pk_mul_f32 v[34:35], v[34:35], v[138:139]
    v_pk_mul_f32 v[36:37], v[36:37], v[140:141]
    v_pk_mul_f32 v[38:39], v[38:39], v[142:143]
    v_pk_mul_f32 v[40:41], v[40:41], v[136:137]
    v_pk_mul_f32 v[42:43], v[42:43], v[138:139]
    v_pk_mul_f32 v[44:45], v[44:45], v[140:141]
    v_pk_mul_f32 v[46:47], v[46:47], v[142:143]
    s_mov_b32 exec_lo, 0x55555555
    s_mov_b32 exec_hi, 0x55555555
    v_pk_mul_f32 v[176:177], v[176:177], v[136:137]
    v_pk_mul_f32 v[178:179], v[178:179], v[138:139]
    v_pk_mul_f32 v[180:181], v[180:181], v[140:141]
    v_pk_mul_f32 v[182:183], v[182:183], v[142:143]
    v_pk_mul_f32 v[184:185], v[184:185], v[136:137]
    v_pk_mul_f32 v[186:187], v[186:187], v[138:139]
    v_pk_mul_f32 v[188:189], v[188:189], v[140:141]
    v_pk_mul_f32 v[190:191], v[190:191], v[142:143]
    s_mov_b64 exec, -1
    v_pk_mul_f32 v[128:129], v[128:129], v[136:137]
    v_pk_mul_f32 v[130:131], v[130:131], v[138:139]
    v_pk_mul_f32 v[132:133], v[132:133], v[140:141]
    v_pk_mul_f32 v[134:135], v[134:135], v[142:143]
    v_pk_mul_f32 v[224:225], v[160:161], v[32:33]
    v_pk_mul_f32 v[226:227], v[162:163], v[34:35]
    v_pk_mul_f32 v[228:229], v[164:165], v[36:37]
    v_pk_mul_f32 v[230:231], v[166:167], v[38:39]
    v_pk_mul_f32 v[232:233], v[168:169], v[40:41]
    v_pk_mul_f32 v[234:235], v[170:171], v[42:43]
    v_pk_mul_f32 v[236:237], v[172:173], v[44:45]
    v_pk_mul_f32 v[238:239], v[174:175], v[46:47]
    v_cvt_pk_bf16_f32 v208, v224, v225
    v_cvt_pk_bf16_f32 v209, v226, v227
    v_cvt_pk_bf16_f32 v210, v228, v229
    v_cvt_pk_bf16_f32 v211, v230, v231
    v_cvt_pk_bf16_f32 v212, v232, v233
    v_cvt_pk_bf16_f32 v213, v234, v235
    v_cvt_pk_bf16_f32 v214, v236, v237
    v_cvt_pk_bf16_f32 v215, v238, v239
    v_pk_mul_f32 v[224:225], v[144:145], v[176:177]
    v_pk_mul_f32 v[226:227], v[146:147], v[178:179]
    v_pk_mul_f32 v[228:229], v[148:149], v[180:181]
    v_pk_mul_f32 v[230:231], v[150:151], v[182:183]
    v_pk_mul_f32 v[232:233], v[152:153], v[184:185]
    v_pk_mul_f32 v[234:235], v[154:155], v[186:187]
    v_pk_mul_f32 v[236:237], v[156:157], v[188:189]
    v_pk_mul_f32 v[238:239], v[158:159], v[190:191]
    v_cvt_pk_bf16_f32 v96, v224, v225
    v_cvt_pk_bf16_f32 v97, v226, v227
    v_cvt_pk_bf16_f32 v98, v228, v229
    v_cvt_pk_bf16_f32 v99, v230, v231
    v_cvt_pk_bf16_f32 v100, v232, v233
    v_cvt_pk_bf16_f32 v101, v234, v235
    v_cvt_pk_bf16_f32 v102, v236, v237
    v_cvt_pk_bf16_f32 v103, v238, v239
    v_mfma_f32_16x16x32_bf16 v[192:195], v[96:99], v[208:211], 0
    v_mfma_f32_16x16x32_bf16 v[196:199], v[96:99], v[212:215], 0
    v_mfma_f32_16x16x32_bf16 v[200:203], v[100:103], v[208:211], 0
    v_mfma_f32_16x16x32_bf16 v[204:207], v[100:103], v[212:215], 0
    s_mov_b32 exec_lo, 0x00c0000c
    s_mov_b32 exec_hi, 0xc0000c00
    s_nop 2
    v_add_f32 v80, v80, v192
    v_add_f32 v84, v84, v196
    v_add_f32 v88, v88, v200
    v_add_f32 v92, v92, v204
    s_mov_b32 exec_lo, 0x00c0000c
    s_mov_b32 exec_hi, 0xc0000c00
    v_add_f32 v81, v81, v193
    v_add_f32 v85, v85, v197
    v_add_f32 v89, v89, v201
    v_add_f32 v93, v93, v205
    s_mov_b32 exec_lo, 0x00000000
    s_mov_b32 exec_hi, 0x00000000
    v_add_f32 v82, v82, v194
    v_add_f32 v86, v86, v198
    v_add_f32 v90, v90, v202
    v_add_f32 v94, v94, v206
    s_mov_b32 exec_lo, 0x00000000
    s_mov_b32 exec_hi, 0x00000000
    v_add_f32 v83, v83, v195
    v_add_f32 v87, v87, v199
    v_add_f32 v91, v91, v203
    v_add_f32 v95, v95, v207
    s_mov_b64 exec, -1
    v_mov_b32_dpp v136, v128 quad_perm:[2,3,0,1] row_mask:0xf bank_mask:0xf
    v_mov_b32_dpp v137, v129 quad_perm:[2,3,0,1] row_mask:0xf bank_mask:0xf
    v_mov_b32_dpp v138, v130 quad_perm:[2,3,0,1] row_mask:0xf bank_mask:0xf
    v_mov_b32_dpp v139, v131 quad_perm:[2,3,0,1] row_mask:0xf bank_mask:0xf
    v_mov_b32_dpp v140, v132 quad_perm:[2,3,0,1] row_mask:0xf bank_mask:0xf
    v_mov_b32_dpp v141, v133 quad_perm:[2,3,0,1] row_mask:0xf bank_mask:0xf
    v_mov_b32_dpp v142, v134 quad_perm:[2,3,0,1] row_mask:0xf bank_mask:0xf
    v_mov_b32_dpp v143, v135 quad_perm:[2,3,0,1] row_mask:0xf bank_mask:0xf
    s_mov_b32 exec_lo, 0xcccccccc
    s_mov_b32 exec_hi, 0xcccccccc
    v_pk_mul_f32 v[32:33], v[32:33], v[136:137]
    v_pk_mul_f32 v[34:35], v[34:35], v[138:139]
    v_pk_mul_f32 v[36:37], v[36:37], v[140:141]
    v_pk_mul_f32 v[38:39], v[38:39], v[142:143]
    v_pk_mul_f32 v[40:41], v[40:41], v[136:137]
    v_pk_mul_f32 v[42:43], v[42:43], v[138:139]
    v_pk_mul_f32 v[44:45], v[44:45], v[140:141]
    v_pk_mul_f32 v[46:47], v[46:47], v[142:143]
    s_mov_b32 exec_lo, 0x33333333
    s_mov_b32 exec_hi, 0x33333333
    v_pk_mul_f32 v[176:177], v[176:177], v[136:137]
    v_pk_mul_f32 v[178:179], v[178:179], v[138:139]
    v_pk_mul_f32 v[180:181], v[180:181], v[140:141]
    v_pk_mul_f32 v[182:183], v[182:183], v[142:143]
    v_pk_mul_f32 v[184:185], v[184:185], v[136:137]
    v_pk_mul_f32 v[186:187], v[186:187], v[138:139]
    v_pk_mul_f32 v[188:189], v[188:189], v[140:141]
    v_pk_mul_f32 v[190:191], v[190:191], v[142:143]
    s_mov_b64 exec, -1
    v_pk_mul_f32 v[128:129], v[128:129], v[136:137]
    v_pk_mul_f32 v[130:131], v[130:131], v[138:139]
    v_pk_mul_f32 v[132:133], v[132:133], v[140:141]
    v_pk_mul_f32 v[134:135], v[134:135], v[142:143]
    v_pk_mul_f32 v[224:225], v[160:161], v[32:33]
    v_pk_mul_f32 v[226:227], v[162:163], v[34:35]
    v_pk_mul_f32 v[228:229], v[164:165], v[36:37]
    v_pk_mul_f32 v[230:231], v[166:167], v[38:39]
    v_pk_mul_f32 v[232:233], v[168:169], v[40:41]
    v_pk_mul_f32 v[234:235], v[170:171], v[42:43]
    v_pk_mul_f32 v[236:237], v[172:173], v[44:45]
    v_pk_mul_f32 v[238:239], v[174:175], v[46:47]
    v_cvt_pk_bf16_f32 v208, v224, v225
    v_cvt_pk_bf16_f32 v209, v226, v227
    v_cvt_pk_bf16_f32 v210, v228, v229
    v_cvt_pk_bf16_f32 v211, v230, v231
    v_cvt_pk_bf16_f32 v212, v232, v233
    v_cvt_pk_bf16_f32 v213, v234, v235
    v_cvt_pk_bf16_f32 v214, v236, v237
    v_cvt_pk_bf16_f32 v215, v238, v239
    v_pk_mul_f32 v[224:225], v[144:145], v[176:177]
    v_pk_mul_f32 v[226:227], v[146:147], v[178:179]
    v_pk_mul_f32 v[228:229], v[148:149], v[180:181]
    v_pk_mul_f32 v[230:231], v[150:151], v[182:183]
    v_pk_mul_f32 v[232:233], v[152:153], v[184:185]
    v_pk_mul_f32 v[234:235], v[154:155], v[186:187]
    v_pk_mul_f32 v[236:237], v[156:157], v[188:189]
    v_pk_mul_f32 v[238:239], v[158:159], v[190:191]
    v_cvt_pk_bf16_f32 v96, v224, v225
    v_cvt_pk_bf16_f32 v97, v226, v227
    v_cvt_pk_bf16_f32 v98, v228, v229
    v_cvt_pk_bf16_f32 v99, v230, v231
    v_cvt_pk_bf16_f32 v100, v232, v233
    v_cvt_pk_bf16_f32 v101, v234, v235
    v_cvt_pk_bf16_f32 v102, v236, v237
    v_cvt_pk_bf16_f32 v103, v238, v239
    v_mfma_f32_16x16x32_bf16 v[192:195], v[96:99], v[208:211], 0
    v_mfma_f32_16x16x32_bf16 v[196:199], v[96:99], v[212:215], 0
    v_mfma_f32_16x16x32_bf16 v[200:203], v[100:103], v[208:211], 0
    v_mfma_f32_16x16x32_bf16 v[204:207], v[100:103], v[212:215], 0
    s_mov_b32 exec_lo, 0x000000f0
    s_mov_b32 exec_hi, 0x0000f000
    s_nop 2
    v_add_f32 v80, v80, v192
    v_add_f32 v84, v84, v196
    v_add_f32 v88, v88, v200
    v_add_f32 v92, v92, v204
    s_mov_b32 exec_lo, 0x000000f0
    s_mov_b32 exec_hi, 0x0000f000
    v_add_f32 v81, v81, v193
    v_add_f32 v85, v85, v197
    v_add_f32 v89, v89, v201
    v_add_f32 v93, v93, v205
    s_mov_b32 exec_lo, 0x000000f0
    s_mov_b32 exec_hi, 0x0000f000
    v_add_f32 v82, v82, v194
    v_add_f32 v86, v86, v198
    v_add_f32 v90, v90, v202
    v_add_f32 v94, v94, v206
    s_mov_b32 exec_lo, 0x000000f0
    s_mov_b32 exec_hi, 0x0000f000
    v_add_f32 v83, v83, v195
    v_add_f32 v87, v87, v199
    v_add_f32 v91, v91, v203
    v_add_f32 v95, v95, v207
    s_mov_b64 exec, -1
    v_mov_b32_dpp v136, v128 row_half_mirror row_mask:0xf bank_mask:0xf
    v_mov_b32_dpp v137, v129 row_half_mirror row_mask:0xf bank_mask:0xf
    v_mov_b32_dpp v138, v130 row_half_mirror row_mask:0xf bank_mask:0xf
    v_mov_b32_dpp v139, v131 row_half_mirror row_mask:0xf bank_mask:0xf
    v_mov_b32_dpp v140, v132 row_half_mirror row_mask:0xf bank_mask:0xf
    v_mov_b32_dpp v141, v133 row_half_mirror row_mask:0xf bank_mask:0xf
    v_mov_b32_dpp v142, v134 row_half_mirror row_mask:0xf bank_mask:0xf
    v_mov_b32_dpp v143, v135 row_half_mirror row_mask:0xf bank_mask:0xf
    s_mov_b32 exec_lo, 0xf0f0f0f0
    s_mov_b32 exec_hi, 0xf0f0f0f0
    v_pk_mul_f32 v[32:33], v[32:33], v[136:137]
    v_pk_mul_f32 v[34:35], v[34:35], v[138:139]
    v_pk_mul_f32 v[36:37], v[36:37], v[140:141]
    v_pk_mul_f32 v[38:39], v[38:39], v[142:143]
    v_pk_mul_f32 v[40:41], v[40:41], v[136:137]
    v_pk_mul_f32 v[42:43], v[42:43], v[138:139]
    v_pk_mul_f32 v[44:45], v[44:45], v[140:141]
    v_pk_mul_f32 v[46:47], v[46:47], v[142:143]
    s_mov_b32 exec_lo, 0x0f0f0f0f
    s_mov_b32 exec_hi, 0x0f0f0f0f
    v_pk_mul_f32 v[176:177], v[176:177], v[136:137]
    v_pk_mul_f32 v[178:179], v[178:179], v[138:139]
    v_pk_mul_f32 v[180:181], v[180:181], v[140:141]
    v_pk_mul_f32 v[182:183], v[182:183], v[142:143]
    v_pk_mul_f32 v[184:185], v[184:185], v[136:137]
    v_pk_mul_f32 v[186:187], v[186:187], v[138:139]
    v_pk_mul_f32 v[188:189], v[188:189], v[140:141]
    v_pk_mul_f32 v[190:191], v[190:191], v[142:143]
    s_mov_b64 exec, -1
    v_pk_mul_f32 v[128:129], v[128:129], v[136:137]
    v_pk_mul_f32 v[130:131], v[130:131], v[138:139]
    v_pk_mul_f32 v[132:133], v[132:133], v[140:141]
    v_pk_mul_f32 v[134:135], v[134:135], v[142:143]
    v_pk_mul_f32 v[224:225], v[160:161], v[32:33]
    v_pk_mul_f32 v[226:227], v[162:163], v[34:35]
    v_pk_mul_f32 v[228:229], v[164:165], v[36:37]
    v_pk_mul_f32 v[230:231], v[166:167], v[38:39]
    v_pk_mul_f32 v[232:233], v[168:169], v[40:41]
    v_pk_mul_f32 v[234:235], v[170:171], v[42:43]
    v_pk_mul_f32 v[236:237], v[172:173], v[44:45]
    v_pk_mul_f32 v[238:239], v[174:175], v[46:47]
    v_cvt_pk_bf16_f32 v208, v224, v225
    v_cvt_pk_bf16_f32 v209, v226, v227
    v_cvt_pk_bf16_f32 v210, v228, v229
    v_cvt_pk_bf16_f32 v211, v230, v231
    v_cvt_pk_bf16_f32 v212, v232, v233
    v_cvt_pk_bf16_f32 v213, v234, v235
    v_cvt_pk_bf16_f32 v214, v236, v237
    v_cvt_pk_bf16_f32 v215, v238, v239
    v_pk_mul_f32 v[224:225], v[144:145], v[176:177]
    v_pk_mul_f32 v[226:227], v[146:147], v[178:179]
    v_pk_mul_f32 v[228:229], v[148:149], v[180:181]
    v_pk_mul_f32 v[230:231], v[150:151], v[182:183]
    v_pk_mul_f32 v[232:233], v[152:153], v[184:185]
    v_pk_mul_f32 v[234:235], v[154:155], v[186:187]
    v_pk_mul_f32 v[236:237], v[156:157], v[188:189]
    v_pk_mul_f32 v[238:239], v[158:159], v[190:191]
    v_cvt_pk_bf16_f32 v96, v224, v225
    v_cvt_pk_bf16_f32 v97, v226, v227
    v_cvt_pk_bf16_f32 v98, v228, v229
    v_cvt_pk_bf16_f32 v99, v230, v231
    v_cvt_pk_bf16_f32 v100, v232, v233
    v_cvt_pk_bf16_f32 v101, v234, v235
    v_cvt_pk_bf16_f32 v102, v236, v237
    v_cvt_pk_bf16_f32 v103, v238, v239
    v_mfma_f32_16x16x32_bf16 v[192:195], v[96:99], v[208:211], 0
    v_mfma_f32_16x16x32_bf16 v[196:199], v[96:99], v[212:215], 0
    v_mfma_f32_16x16x32_bf16 v[200:203], v[100:103], v[208:211], 0
    v_mfma_f32_16x16x32_bf16 v[204:207], v[100:103], v[212:215], 0
    s_mov_b32 exec_lo, 0xff00ff00
    s_mov_b32 exec_hi, 0x00000000
    s_nop 2
    v_add_f32 v80, v80, v192
    v_add_f32 v84, v84, v196
    v_add_f32 v88, v88, v200
    v_add_f32 v92, v92, v204
    s_mov_b32 exec_lo, 0xff00ff00
    s_mov_b32 exec_hi, 0x00000000
    v_add_f32 v81, v81, v193
    v_add_f32 v85, v85, v197
    v_add_f32 v89, v89, v201
    v_add_f32 v93, v93, v205
    s_mov_b32 exec_lo, 0xff00ff00
    s_mov_b32 exec_hi, 0x00000000
    v_add_f32 v82, v82, v194
    v_add_f32 v86, v86, v198
    v_add_f32 v90, v90, v202
    v_add_f32 v94, v94, v206
    s_mov_b32 exec_lo, 0xff00ff00
    s_mov_b32 exec_hi, 0x00000000
    v_add_f32 v83, v83, v195
    v_add_f32 v87, v87, v199
    v_add_f32 v91, v91, v203
    v_add_f32 v95, v95, v207
    s_mov_b64 exec, -1
    v_mov_b32_dpp v136, v128 row_mirror row_mask:0xf bank_mask:0xf
    v_mov_b32_dpp v137, v129 row_mirror row_mask:0xf bank_mask:0xf
    v_mov_b32_dpp v138, v130 row_mirror row_mask:0xf bank_mask:0xf
    v_mov_b32_dpp v139, v131 row_mirror row_mask:0xf bank_mask:0xf
    v_mov_b32_dpp v140, v132 row_mirror row_mask:0xf bank_mask:0xf
    v_mov_b32_dpp v141, v133 row_mirror row_mask:0xf bank_mask:0xf
    v_mov_b32_dpp v142, v134 row_mirror row_mask:0xf bank_mask:0xf
    v_mov_b32_dpp v143, v135 row_mirror row_mask:0xf bank_mask:0xf
    s_mov_b32 exec_lo, 0xff00ff00
    s_mov_b32 exec_hi, 0xff00ff00
    v_pk_mul_f32 v[32:33], v[32:33], v[136:137]
    v_pk_mul_f32 v[34:35], v[34:35], v[138:139]
    v_pk_mul_f32 v[36:37], v[36:37], v[140:141]
    v_pk_mul_f32 v[38:39], v[38:39], v[142:143]
    v_pk_mul_f32 v[40:41], v[40:41], v[136:137]
    v_pk_mul_f32 v[42:43], v[42:43], v[138:139]
    v_pk_mul_f32 v[44:45], v[44:45], v[140:141]
    v_pk_mul_f32 v[46:47], v[46:47], v[142:143]
    s_mov_b32 exec_lo, 0x00ff00ff
    s_mov_b32 exec_hi, 0x00ff00ff
    v_pk_mul_f32 v[176:177], v[176:177], v[136:137]
    v_pk_mul_f32 v[178:179], v[178:179], v[138:139]
    v_pk_mul_f32 v[180:181], v[180:181], v[140:141]
    v_pk_mul_f32 v[182:183], v[182:183], v[142:143]
    v_pk_mul_f32 v[184:185], v[184:185], v[136:137]
    v_pk_mul_f32 v[186:187], v[186:187], v[138:139]
    v_pk_mul_f32 v[188:189], v[188:189], v[140:141]
    v_pk_mul_f32 v[190:191], v[190:191], v[142:143]
    s_mov_b64 exec, -1
    v_pk_mul_f32 v[128:129], v[128:129], v[136:137]
    v_pk_mul_f32 v[130:131], v[130:131], v[138:139]
    v_pk_mul_f32 v[132:133], v[132:133], v[140:141]
    v_pk_mul_f32 v[134:135], v[134:135], v[142:143]
    v_pk_mul_f32 v[224:225], v[144:145], v[176:177]
    v_pk_mul_f32 v[226:227], v[146:147], v[178:179]
    v_pk_mul_f32 v[228:229], v[148:149], v[180:181]
    v_pk_mul_f32 v[230:231], v[150:151], v[182:183]
    v_pk_mul_f32 v[232:233], v[152:153], v[184:185]
    v_pk_mul_f32 v[234:235], v[154:155], v[186:187]
    v_pk_mul_f32 v[236:237], v[156:157], v[188:189]
    v_pk_mul_f32 v[238:239], v[158:159], v[190:191]
    v_cvt_pk_bf16_f32 v96, v224, v225
    v_cvt_pk_bf16_f32 v97, v226, v227
    v_cvt_pk_bf16_f32 v98, v228, v229
    v_cvt_pk_bf16_f32 v99, v230, v231
    v_cvt_pk_bf16_f32 v100, v232, v233
    v_cvt_pk_bf16_f32 v101, v234, v235
    v_cvt_pk_bf16_f32 v102, v236, v237
    v_cvt_pk_bf16_f32 v103, v238, v239
    ds_write_b64 v10, v[96:97] offset:0
    ds_write_b64 v11, v[98:99] offset:0
    ds_write_b64 v11, v[100:101] offset:256
    ds_write_b64 v10, v[102:103] offset:256
    s_mov_b32 exec_lo, 0x80008000
    s_mov_b32 exec_hi, 0x80008000
    ds_write_b128 v5, v[40:43] offset:32
    ds_write_b128 v5, v[44:47] offset:48
    s_mov_b64 exec, -1
    ds_read_b64_tr_b16 v[224:225], v240 offset:0
    ds_read_b64_tr_b16 v[226:227], v241 offset:512
    ds_read_b64_tr_b16 v[228:229], v241 offset:0
    s_waitcnt lgkmcnt(14)
    ds_read_b64_tr_b16 v[230:231], v240 offset:512
    s_waitcnt lgkmcnt(14)
    ds_read_b64_tr_b16 v[232:233], v242 offset:0
    s_waitcnt lgkmcnt(14)
    ds_read_b64_tr_b16 v[234:235], v243 offset:512
    s_waitcnt lgkmcnt(14)
    ds_read_b64_tr_b16 v[236:237], v243 offset:0
    s_waitcnt lgkmcnt(14)
    ds_read_b64_tr_b16 v[238:239], v242 offset:512
    s_waitcnt lgkmcnt(0)
    ds_write_b128 v244, v[224:227] offset:0
    ds_write_b128 v244, v[228:231] offset:1024
    ds_write_b128 v244, v[232:235] offset:2048
    ds_write_b128 v244, v[236:239] offset:3072
    buffer_load_dwordx4 v[224:227], v104, s[44:47], s6 offen offset:128
    buffer_load_dwordx4 v[228:231], v104, s[44:47], s6 offen offset:384
    buffer_load_dwordx4 v[232:235], v104, s[36:39], s6 offen offset:128
    buffer_load_dwordx4 v[236:239], v104, s[36:39], s6 offen offset:384
    buffer_load_dwordx4 v[208:211], v104, s[32:35], s6 offen offset:128
    buffer_load_dwordx4 v[212:215], v104, s[32:35], s6 offen offset:384
    s_waitcnt vmcnt(0)
    v_lshlrev_b32 v112, 16, v224
    v_and_b32 v113, 0xffff0000, v224
    v_lshlrev_b32 v114, 16, v225
    v_and_b32 v115, 0xffff0000, v225
    v_lshlrev_b32 v116, 16, v226
    v_and_b32 v117, 0xffff0000, v226
    v_lshlrev_b32 v118, 16, v227
    v_and_b32 v119, 0xffff0000, v227
    v_lshlrev_b32 v120, 16, v228
    v_and_b32 v121, 0xffff0000, v228
    v_lshlrev_b32 v122, 16, v229
    v_and_b32 v123, 0xffff0000, v229
    v_lshlrev_b32 v124, 16, v230
    v_and_b32 v125, 0xffff0000, v230
    v_lshlrev_b32 v126, 16, v231
    v_and_b32 v127, 0xffff0000, v231
    v_lshlrev_b32 v144, 16, v232
    v_and_b32 v145, 0xffff0000, v232
    v_lshlrev_b32 v146, 16, v233
    v_and_b32 v147, 0xffff0000, v233
    v_lshlrev_b32 v148, 16, v234
    v_and_b32 v149, 0xffff0000, v234
    v_lshlrev_b32 v150, 16, v235
    v_and_b32 v151, 0xffff0000, v235
    v_lshlrev_b32 v152, 16, v236
    v_and_b32 v153, 0xffff0000, v236
    v_lshlrev_b32 v154, 16, v237
    v_and_b32 v155, 0xffff0000, v237
    v_lshlrev_b32 v156, 16, v238
    v_and_b32 v157, 0xffff0000, v238
    v_lshlrev_b32 v158, 16, v239
    v_and_b32 v159, 0xffff0000, v239
    v_lshlrev_b32 v160, 16, v208
    v_and_b32 v161, 0xffff0000, v208
    v_lshlrev_b32 v162, 16, v209
    v_and_b32 v163, 0xffff0000, v209
    v_lshlrev_b32 v164, 16, v210
    v_and_b32 v165, 0xffff0000, v210
    v_lshlrev_b32 v166, 16, v211
    v_and_b32 v167, 0xffff0000, v211
    v_lshlrev_b32 v168, 16, v212
    v_and_b32 v169, 0xffff0000, v212
    v_lshlrev_b32 v170, 16, v213
    v_and_b32 v171, 0xffff0000, v213
    v_lshlrev_b32 v172, 16, v214
    v_and_b32 v173, 0xffff0000, v214
    v_lshlrev_b32 v174, 16, v215
    v_and_b32 v175, 0xffff0000, v215
    v_pk_mul_f32 v[144:145], v[144:145], s[12:13]
    v_pk_mul_f32 v[146:147], v[146:147], s[12:13]
    v_pk_mul_f32 v[148:149], v[148:149], s[12:13]
    v_pk_mul_f32 v[150:151], v[150:151], s[12:13]
    v_pk_mul_f32 v[152:153], v[152:153], s[12:13]
    v_pk_mul_f32 v[154:155], v[154:155], s[12:13]
    v_pk_mul_f32 v[156:157], v[156:157], s[12:13]
    v_pk_mul_f32 v[158:159], v[158:159], s[12:13]
    v_cvt_pk_bf16_f32 v232, v144, v145
    v_cvt_pk_bf16_f32 v233, v146, v147
    v_cvt_pk_bf16_f32 v234, v148, v149
    v_cvt_pk_bf16_f32 v235, v150, v151
    v_cvt_pk_bf16_f32 v236, v152, v153
    v_cvt_pk_bf16_f32 v237, v154, v155
    v_cvt_pk_bf16_f32 v238, v156, v157
    v_cvt_pk_bf16_f32 v239, v158, v159
    v_pk_mul_f32 v[112:113], v[112:113], s[8:9]
    v_pk_mul_f32 v[114:115], v[114:115], s[8:9]
    v_pk_mul_f32 v[116:117], v[116:117], s[8:9]
    v_pk_mul_f32 v[118:119], v[118:119], s[8:9]
    v_pk_mul_f32 v[120:121], v[120:121], s[8:9]
    v_pk_mul_f32 v[122:123], v[122:123], s[8:9]
    v_pk_mul_f32 v[124:125], v[124:125], s[8:9]
    v_pk_mul_f32 v[126:127], v[126:127], s[8:9]
    v_exp_f32 v112, v112
    v_exp_f32 v113, v113
    v_exp_f32 v114, v114
    v_exp_f32 v115, v115
    v_exp_f32 v116, v116
    v_exp_f32 v117, v117
    v_exp_f32 v118, v118
    v_exp_f32 v119, v119
    v_exp_f32 v120, v120
    v_exp_f32 v121, v121
    v_exp_f32 v122, v122
    v_exp_f32 v123, v123
    v_exp_f32 v124, v124
    v_exp_f32 v125, v125
    v_exp_f32 v126, v126
    v_exp_f32 v127, v127
    v_pk_add_f32 v[112:113], v[112:113], s[10:11]
    v_pk_add_f32 v[114:115], v[114:115], s[10:11]
    v_pk_add_f32 v[116:117], v[116:117], s[10:11]
    v_pk_add_f32 v[118:119], v[118:119], s[10:11]
    v_pk_add_f32 v[120:121], v[120:121], s[10:11]
    v_pk_add_f32 v[122:123], v[122:123], s[10:11]
    v_pk_add_f32 v[124:125], v[124:125], s[10:11]
    v_pk_add_f32 v[126:127], v[126:127], s[10:11]
    v_rcp_f32 v112, v112
    v_rcp_f32 v113, v113
    v_rcp_f32 v114, v114
    v_rcp_f32 v115, v115
    v_rcp_f32 v116, v116
    v_rcp_f32 v117, v117
    v_rcp_f32 v118, v118
    v_rcp_f32 v119, v119
    v_rcp_f32 v120, v120
    v_rcp_f32 v121, v121
    v_rcp_f32 v122, v122
    v_rcp_f32 v123, v123
    v_rcp_f32 v124, v124
    v_rcp_f32 v125, v125
    v_rcp_f32 v126, v126
    v_rcp_f32 v127, v127
    v_pk_mul_f32 v[136:137], v[168:169], v[120:121]
    v_pk_mul_f32 v[138:139], v[170:171], v[122:123]
    v_pk_mul_f32 v[140:141], v[172:173], v[124:125]
    v_pk_mul_f32 v[142:143], v[174:175], v[126:127]
    v_cvt_pk_bf16_f32 v96, v136, v137
    v_cvt_pk_bf16_f32 v97, v138, v139
    v_cvt_pk_bf16_f32 v98, v140, v141
    v_cvt_pk_bf16_f32 v99, v142, v143
    v_mfma_f32_16x16x32_bf16 v[192:195], v[232:235], v[208:211], 0
    v_mfma_f32_16x16x32_bf16 v[204:207], v[236:239], v[212:215], 0
    v_mfma_f32_16x16x32_bf16 v[196:199], v[232:235], v[96:99], 0
    s_mov_b32 exec_lo, 0x00100001
    s_mov_b32 exec_hi, 0x10000100
    s_nop 3
    v_add_f32 v80, v80, v192
    v_add_f32 v92, v92, v204
    v_add_f32 v84, v84, v196
    s_mov_b32 exec_lo, 0x00200002
    s_mov_b32 exec_hi, 0x20000200
    v_add_f32 v81, v81, v193
    v_add_f32 v93, v93, v205
    v_add_f32 v85, v85, v197
    s_mov_b32 exec_lo, 0x00400004
    s_mov_b32 exec_hi, 0x40000400
    v_add_f32 v82, v82, v194
    v_add_f32 v94, v94, v206
    v_add_f32 v86, v86, v198
    s_mov_b32 exec_lo, 0x00800008
    s_mov_b32 exec_hi, 0x80000800
    v_add_f32 v83, v83, v195
    v_add_f32 v95, v95, v207
    v_add_f32 v87, v87, v199
    s_mov_b64 exec, -1
    v_mov_b32 v48, v112
    v_mov_b32 v176, v120
    v_mov_b32 v184, 1.0
    v_mov_b32 v49, v113
    v_mov_b32 v177, v121
    v_mov_b32 v185, 1.0
    v_mov_b32 v50, v114
    v_mov_b32 v178, v122
    v_mov_b32 v186, 1.0
    v_mov_b32 v51, v115
    v_mov_b32 v179, v123
    v_mov_b32 v187, 1.0
    v_mov_b32 v52, v116
    v_mov_b32 v180, v124
    v_mov_b32 v188, 1.0
    v_mov_b32 v53, v117
    v_mov_b32 v181, v125
    v_mov_b32 v189, 1.0
    v_mov_b32 v54, v118
    v_mov_b32 v182, v126
    v_mov_b32 v190, 1.0
    v_mov_b32 v55, v119
    v_mov_b32 v183, v127
    v_mov_b32 v191, 1.0
    v_pk_mul_f32 v[56:57], v[112:113], v[120:121]
    v_pk_mul_f32 v[58:59], v[114:115], v[122:123]
    v_pk_mul_f32 v[60:61], v[116:117], v[124:125]
    v_pk_mul_f32 v[62:63], v[118:119], v[126:127]
    v_pk_mul_f32 v[128:129], v[112:113], v[120:121]
    v_pk_mul_f32 v[130:131], v[114:115], v[122:123]
    v_pk_mul_f32 v[132:133], v[116:117], v[124:125]
    v_pk_mul_f32 v[134:135], v[118:119], v[126:127]
    v_pk_mul_f32 v[224:225], v[160:161], v[48:49]
    v_pk_mul_f32 v[226:227], v[162:163], v[50:51]
    v_pk_mul_f32 v[228:229], v[164:165], v[52:53]
    v_pk_mul_f32 v[230:231], v[166:167], v[54:55]
    v_pk_mul_f32 v[232:233], v[168:169], v[56:57]
    v_pk_mul_f32 v[234:235], v[170:171], v[58:59]
    v_pk_mul_f32 v[236:237], v[172:173], v[60:61]
    v_pk_mul_f32 v[238:239], v[174:175], v[62:63]
    v_cvt_pk_bf16_f32 v208, v224, v225
    v_cvt_pk_bf16_f32 v209, v226, v227
    v_cvt_pk_bf16_f32 v210, v228, v229
    v_cvt_pk_bf16_f32 v211, v230, v231
    v_cvt_pk_bf16_f32 v212, v232, v233
    v_cvt_pk_bf16_f32 v213, v234, v235
    v_cvt_pk_bf16_f32 v214, v236, v237
    v_cvt_pk_bf16_f32 v215, v238, v239
    v_pk_mul_f32 v[224:225], v[144:145], v[176:177]
    v_pk_mul_f32 v[226:227], v[146:147], v[178:179]
    v_pk_mul_f32 v[228:229], v[148:149], v[180:181]
    v_pk_mul_f32 v[230:231], v[150:151], v[182:183]
    v_pk_mul_f32 v[232:233], v[152:153], v[184:185]
    v_pk_mul_f32 v[234:235], v[154:155], v[186:187]
    v_pk_mul_f32 v[236:237], v[156:157], v[188:189]
    v_pk_mul_f32 v[238:239], v[158:159], v[190:191]
    v_cvt_pk_bf16_f32 v96, v224, v225
    v_cvt_pk_bf16_f32 v97, v226, v227
    v_cvt_pk_bf16_f32 v98, v228, v229
    v_cvt_pk_bf16_f32 v99, v230, v231
    v_cvt_pk_bf16_f32 v100, v232, v233
    v_cvt_pk_bf16_f32 v101, v234, v235
    v_cvt_pk_bf16_f32 v102, v236, v237
    v_cvt_pk_bf16_f32 v103, v238, v239
    v_mfma_f32_16x16x32_bf16 v[192:195], v[96:99], v[208:211], 0
    v_mfma_f32_16x16x32_bf16 v[196:199], v[96:99], v[212:215], 0
    v_mfma_f32_16x16x32_bf16 v[200:203], v[100:103], v[208:211], 0
    v_mfma_f32_16x16x32_bf16 v[204:207], v[100:103], v[212:215], 0
    s_mov_b32 exec_lo, 0x00200002
    s_mov_b32 exec_hi, 0x20000200
    s_nop 2
    v_add_f32 v80, v80, v192
    v_add_f32 v84, v84, v196
    v_add_f32 v88, v88, v200
    v_add_f32 v92, v92, v204
    s_mov_b32 exec_lo, 0x00000000
    s_mov_b32 exec_hi, 0x00000000
    v_add_f32 v81, v81, v193
    v_add_f32 v85, v85, v197
    v_add_f32 v89, v89, v201
    v_add_f32 v93, v93, v205
    s_mov_b32 exec_lo, 0x00800008
    s_mov_b32 exec_hi, 0x80000800
    v_add_f32 v82, v82, v194
    v_add_f32 v86, v86, v198
    v_add_f32 v90, v90, v202
    v_add_f32 v94, v94, v206
    s_mov_b32 exec_lo, 0x00000000
    s_mov_b32 exec_hi, 0x00000000
    v_add_f32 v83, v83, v195
    v_add_f32 v87, v87, v199
    v_add_f32 v91, v91, v203
    v_add_f32 v95, v95, v207
    s_mov_b64 exec, -1
    v_mov_b32_dpp v136, v128 quad_perm:[1,0,3,2] row_mask:0xf bank_mask:0xf
    v_mov_b32_dpp v137, v129 quad_perm:[1,0,3,2] row_mask:0xf bank_mask:0xf
    v_mov_b32_dpp v138, v130 quad_perm:[1,0,3,2] row_mask:0xf bank_mask:0xf
    v_mov_b32_dpp v139, v131 quad_perm:[1,0,3,2] row_mask:0xf bank_mask:0xf
    v_mov_b32_dpp v140, v132 quad_perm:[1,0,3,2] row_mask:0xf bank_mask:0xf
    v_mov_b32_dpp v141, v133 quad_perm:[1,0,3,2] row_mask:0xf bank_mask:0xf
    v_mov_b32_dpp v142, v134 quad_perm:[1,0,3,2] row_mask:0xf bank_mask:0xf
    v_mov_b32_dpp v143, v135 quad_perm:[1,0,3,2] row_mask:0xf bank_mask:0xf
    s_mov_b32 exec_lo, 0xaaaaaaaa
    s_mov_b32 exec_hi, 0xaaaaaaaa
    v_pk_mul_f32 v[48:49], v[48:49], v[136:137]
    v_pk_mul_f32 v[50:51], v[50:51], v[138:139]
    v_pk_mul_f32 v[52:53], v[52:53], v[140:141]
    v_pk_mul_f32 v[54:55], v[54:55], v[142:143]
    v_pk_mul_f32 v[56:57], v[56:57], v[136:137]
    v_pk_mul_f32 v[58:59], v[58:59], v[138:139]
    v_pk_mul_f32 v[60:61], v[60:61], v[140:141]
    v_pk_mul_f32 v[62:63], v[62:63], v[142:143]
    s_mov_b32 exec_lo, 0x55555555
    s_mov_b32 exec_hi, 0x55555555
    v_pk_mul_f32 v[176:177], v[176:177], v[136:137]
    v_pk_mul_f32 v[178:179], v[178:179], v[138:139]
    v_pk_mul_f32 v[180:181], v[180:181], v[140:141]
    v_pk_mul_f32 v[182:183], v[182:183], v[142:143]
    v_pk_mul_f32 v[184:185], v[184:185], v[136:137]
    v_pk_mul_f32 v[186:187], v[186:187], v[138:139]
    v_pk_mul_f32 v[188:189], v[188:189], v[140:141]
    v_pk_mul_f32 v[190:191], v[190:191], v[142:143]
    s_mov_b64 exec, -1
    v_pk_mul_f32 v[128:129], v[128:129], v[136:137]
    v_pk_mul_f32 v[130:131], v[130:131], v[138:139]
    v_pk_mul_f32 v[132:133], v[132:133], v[140:141]
    v_pk_mul_f32 v[134:135], v[134:135], v[142:143]
    v_pk_mul_f32 v[224:225], v[160:161], v[48:49]
    v_pk_mul_f32 v[226:227], v[162:163], v[50:51]
    v_pk_mul_f32 v[228:229], v[164:165], v[52:53]
    v_pk_mul_f32 v[230:231], v[166:167], v[54:55]
    v_pk_mul_f32 v[232:233], v[168:169], v[56:57]
    v_pk_mul_f32 v[234:235], v[170:171], v[58:59]
    v_pk_mul_f32 v[236:237], v[172:173], v[60:61]
    v_pk_mul_f32 v[238:239], v[174:175], v[62:63]
    v_cvt_pk_bf16_f32 v208, v224, v225
    v_cvt_pk_bf16_f32 v209, v226, v227
    v_cvt_pk_bf16_f32 v210, v228, v229
    v_cvt_pk_bf16_f32 v211, v230, v231
    v_cvt_pk_bf16_f32 v212, v232, v233
    v_cvt_pk_bf16_f32 v213, v234, v235
    v_cvt_pk_bf16_f32 v214, v236, v237
    v_cvt_pk_bf16_f32 v215, v238, v239
    v_pk_mul_f32 v[224:225], v[144:145], v[176:177]
    v_pk_mul_f32 v[226:227], v[146:147], v[178:179]
    v_pk_mul_f32 v[228:229], v[148:149], v[180:181]
    v_pk_mul_f32 v[230:231], v[150:151], v[182:183]
    v_pk_mul_f32 v[232:233], v[152:153], v[184:185]
    v_pk_mul_f32 v[234:235], v[154:155], v[186:187]
    v_pk_mul_f32 v[236:237], v[156:157], v[188:189]
    v_pk_mul_f32 v[238:239], v[158:159], v[190:191]
    v_cvt_pk_bf16_f32 v96, v224, v225
    v_cvt_pk_bf16_f32 v97, v226, v227
    v_cvt_pk_bf16_f32 v98, v228, v229
    v_cvt_pk_bf16_f32 v99, v230, v231
    v_cvt_pk_bf16_f32 v100, v232, v233
    v_cvt_pk_bf16_f32 v101, v234, v235
    v_cvt_pk_bf16_f32 v102, v236, v237
    v_cvt_pk_bf16_f32 v103, v238, v239
    v_mfma_f32_16x16x32_bf16 v[192:195], v[96:99], v[208:211], 0
    v_mfma_f32_16x16x32_bf16 v[196:199], v[96:99], v[212:215], 0
    v_mfma_f32_16x16x32_bf16 v[200:203], v[100:103], v[208:211], 0
    v_mfma_f32_16x16x32_bf16 v[204:207], v[100:103], v[212:215], 0
    s_mov_b32 exec_lo, 0x00c0000c
    s_mov_b32 exec_hi, 0xc0000c00
    s_nop 2
    v_add_f32 v80, v80, v192
    v_add_f32 v84, v84, v196
    v_add_f32 v88, v88, v200
    v_add_f32 v92, v92, v204
    s_mov_b32 exec_lo, 0x00c0000c
    s_mov_b32 exec_hi, 0xc0000c00
    v_add_f32 v81, v81, v193
    v_add_f32 v85, v85, v197
    v_add_f32 v89, v89, v201
    v_add_f32 v93, v93, v205
    s_mov_b32 exec_lo, 0x00000000
    s_mov_b32 exec_hi, 0x00000000
    v_add_f32 v82, v82, v194
    v_add_f32 v86, v86, v198
    v_add_f32 v90, v90, v202
    v_add_f32 v94, v94, v206
    s_mov_b32 exec_lo, 0x00000000
    s_mov_b32 exec_hi, 0x00000000
    v_add_f32 v83, v83, v195
    v_add_f32 v87, v87, v199
    v_add_f32 v91, v91, v203
    v_add_f32 v95, v95, v207
    s_mov_b64 exec, -1
    v_mov_b32_dpp v136, v128 quad_perm:[2,3,0,1] row_mask:0xf bank_mask:0xf
    v_mov_b32_dpp v137, v129 quad_perm:[2,3,0,1] row_mask:0xf bank_mask:0xf
    v_mov_b32_dpp v138, v130 quad_perm:[2,3,0,1] row_mask:0xf bank_mask:0xf
    v_mov_b32_dpp v139, v131 quad_perm:[2,3,0,1] row_mask:0xf bank_mask:0xf
    v_mov_b32_dpp v140, v132 quad_perm:[2,3,0,1] row_mask:0xf bank_mask:0xf
    v_mov_b32_dpp v141, v133 quad_perm:[2,3,0,1] row_mask:0xf bank_mask:0xf
    v_mov_b32_dpp v142, v134 quad_perm:[2,3,0,1] row_mask:0xf bank_mask:0xf
    v_mov_b32_dpp v143, v135 quad_perm:[2,3,0,1] row_mask:0xf bank_mask:0xf
    s_mov_b32 exec_lo, 0xcccccccc
    s_mov_b32 exec_hi, 0xcccccccc
    v_pk_mul_f32 v[48:49], v[48:49], v[136:137]
    v_pk_mul_f32 v[50:51], v[50:51], v[138:139]
    v_pk_mul_f32 v[52:53], v[52:53], v[140:141]
    v_pk_mul_f32 v[54:55], v[54:55], v[142:143]
    v_pk_mul_f32 v[56:57], v[56:57], v[136:137]
    v_pk_mul_f32 v[58:59], v[58:59], v[138:139]
    v_pk_mul_f32 v[60:61], v[60:61], v[140:141]
    v_pk_mul_f32 v[62:63], v[62:63], v[142:143]
    s_mov_b32 exec_lo, 0x33333333
    s_mov_b32 exec_hi, 0x33333333
    v_pk_mul_f32 v[176:177], v[176:177], v[136:137]
    v_pk_mul_f32 v[178:179], v[178:179], v[138:139]
    v_pk_mul_f32 v[180:181], v[180:181], v[140:141]
    v_pk_mul_f32 v[182:183], v[182:183], v[142:143]
    v_pk_mul_f32 v[184:185], v[184:185], v[136:137]
    v_pk_mul_f32 v[186:187], v[186:187], v[138:139]
    v_pk_mul_f32 v[188:189], v[188:189], v[140:141]
    v_pk_mul_f32 v[190:191], v[190:191], v[142:143]
    s_mov_b64 exec, -1
    v_pk_mul_f32 v[128:129], v[128:129], v[136:137]
    v_pk_mul_f32 v[130:131], v[130:131], v[138:139]
    v_pk_mul_f32 v[132:133], v[132:133], v[140:141]
    v_pk_mul_f32 v[134:135], v[134:135], v[142:143]
    v_pk_mul_f32 v[224:225], v[160:161], v[48:49]
    v_pk_mul_f32 v[226:227], v[162:163], v[50:51]
    v_pk_mul_f32 v[228:229], v[164:165], v[52:53]
    v_pk_mul_f32 v[230:231], v[166:167], v[54:55]
    v_pk_mul_f32 v[232:233], v[168:169], v[56:57]
    v_pk_mul_f32 v[234:235], v[170:171], v[58:59]
    v_pk_mul_f32 v[236:237], v[172:173], v[60:61]
    v_pk_mul_f32 v[238:239], v[174:175], v[62:63]
    v_cvt_pk_bf16_f32 v208, v224, v225
    v_cvt_pk_bf16_f32 v209, v226, v227
    v_cvt_pk_bf16_f32 v210, v228, v229
    v_cvt_pk_bf16_f32 v211, v230, v231
    v_cvt_pk_bf16_f32 v212, v232, v233
    v_cvt_pk_bf16_f32 v213, v234, v235
    v_cvt_pk_bf16_f32 v214, v236, v237
    v_cvt_pk_bf16_f32 v215, v238, v239
    v_pk_mul_f32 v[224:225], v[144:145], v[176:177]
    v_pk_mul_f32 v[226:227], v[146:147], v[178:179]
    v_pk_mul_f32 v[228:229], v[148:149], v[180:181]
    v_pk_mul_f32 v[230:231], v[150:151], v[182:183]
    v_pk_mul_f32 v[232:233], v[152:153], v[184:185]
    v_pk_mul_f32 v[234:235], v[154:155], v[186:187]
    v_pk_mul_f32 v[236:237], v[156:157], v[188:189]
    v_pk_mul_f32 v[238:239], v[158:159], v[190:191]
    v_cvt_pk_bf16_f32 v96, v224, v225
    v_cvt_pk_bf16_f32 v97, v226, v227
    v_cvt_pk_bf16_f32 v98, v228, v229
    v_cvt_pk_bf16_f32 v99, v230, v231
    v_cvt_pk_bf16_f32 v100, v232, v233
    v_cvt_pk_bf16_f32 v101, v234, v235
    v_cvt_pk_bf16_f32 v102, v236, v237
    v_cvt_pk_bf16_f32 v103, v238, v239
    v_mfma_f32_16x16x32_bf16 v[192:195], v[96:99], v[208:211], 0
    v_mfma_f32_16x16x32_bf16 v[196:199], v[96:99], v[212:215], 0
    v_mfma_f32_16x16x32_bf16 v[200:203], v[100:103], v[208:211], 0
    v_mfma_f32_16x16x32_bf16 v[204:207], v[100:103], v[212:215], 0
    s_mov_b32 exec_lo, 0x000000f0
    s_mov_b32 exec_hi, 0x0000f000
    s_nop 2
    v_add_f32 v80, v80, v192
    v_add_f32 v84, v84, v196
    v_add_f32 v88, v88, v200
    v_add_f32 v92, v92, v204
    s_mov_b32 exec_lo, 0x000000f0
    s_mov_b32 exec_hi, 0x0000f000
    v_add_f32 v81, v81, v193
    v_add_f32 v85, v85, v197
    v_add_f32 v89, v89, v201
    v_add_f32 v93, v93, v205
    s_mov_b32 exec_lo, 0x000000f0
    s_mov_b32 exec_hi, 0x0000f000
    v_add_f32 v82, v82, v194
    v_add_f32 v86, v86, v198
    v_add_f32 v90, v90, v202
    v_add_f32 v94, v94, v206
    s_mov_b32 exec_lo, 0x000000f0
    s_mov_b32 exec_hi, 0x0000f000
    v_add_f32 v83, v83, v195
    v_add_f32 v87, v87, v199
    v_add_f32 v91, v91, v203
    v_add_f32 v95, v95, v207
    s_mov_b64 exec, -1
    v_mov_b32_dpp v136, v128 row_half_mirror row_mask:0xf bank_mask:0xf
    v_mov_b32_dpp v137, v129 row_half_mirror row_mask:0xf bank_mask:0xf
    v_mov_b32_dpp v138, v130 row_half_mirror row_mask:0xf bank_mask:0xf
    v_mov_b32_dpp v139, v131 row_half_mirror row_mask:0xf bank_mask:0xf
    v_mov_b32_dpp v140, v132 row_half_mirror row_mask:0xf bank_mask:0xf
    v_mov_b32_dpp v141, v133 row_half_mirror row_mask:0xf bank_mask:0xf
    v_mov_b32_dpp v142, v134 row_half_mirror row_mask:0xf bank_mask:0xf
    v_mov_b32_dpp v143, v135 row_half_mirror row_mask:0xf bank_mask:0xf
    s_mov_b32 exec_lo, 0xf0f0f0f0
    s_mov_b32 exec_hi, 0xf0f0f0f0
    v_pk_mul_f32 v[48:49], v[48:49], v[136:137]
    v_pk_mul_f32 v[50:51], v[50:51], v[138:139]
    v_pk_mul_f32 v[52:53], v[52:53], v[140:141]
    v_pk_mul_f32 v[54:55], v[54:55], v[142:143]
    v_pk_mul_f32 v[56:57], v[56:57], v[136:137]
    v_pk_mul_f32 v[58:59], v[58:59], v[138:139]
    v_pk_mul_f32 v[60:61], v[60:61], v[140:141]
    v_pk_mul_f32 v[62:63], v[62:63], v[142:143]
    s_mov_b32 exec_lo, 0x0f0f0f0f
    s_mov_b32 exec_hi, 0x0f0f0f0f
    v_pk_mul_f32 v[176:177], v[176:177], v[136:137]
    v_pk_mul_f32 v[178:179], v[178:179], v[138:139]
    v_pk_mul_f32 v[180:181], v[180:181], v[140:141]
    v_pk_mul_f32 v[182:183], v[182:183], v[142:143]
    v_pk_mul_f32 v[184:185], v[184:185], v[136:137]
    v_pk_mul_f32 v[186:187], v[186:187], v[138:139]
    v_pk_mul_f32 v[188:189], v[188:189], v[140:141]
    v_pk_mul_f32 v[190:191], v[190:191], v[142:143]
    s_mov_b64 exec, -1
    v_pk_mul_f32 v[128:129], v[128:129], v[136:137]
    v_pk_mul_f32 v[130:131], v[130:131], v[138:139]
    v_pk_mul_f32 v[132:133], v[132:133], v[140:141]
    v_pk_mul_f32 v[134:135], v[134:135], v[142:143]
    v_pk_mul_f32 v[224:225], v[160:161], v[48:49]
    v_pk_mul_f32 v[226:227], v[162:163], v[50:51]
    v_pk_mul_f32 v[228:229], v[164:165], v[52:53]
    v_pk_mul_f32 v[230:231], v[166:167], v[54:55]
    v_pk_mul_f32 v[232:233], v[168:169], v[56:57]
    v_pk_mul_f32 v[234:235], v[170:171], v[58:59]
    v_pk_mul_f32 v[236:237], v[172:173], v[60:61]
    v_pk_mul_f32 v[238:239], v[174:175], v[62:63]
    v_cvt_pk_bf16_f32 v208, v224, v225
    v_cvt_pk_bf16_f32 v209, v226, v227
    v_cvt_pk_bf16_f32 v210, v228, v229
    v_cvt_pk_bf16_f32 v211, v230, v231
    v_cvt_pk_bf16_f32 v212, v232, v233
    v_cvt_pk_bf16_f32 v213, v234, v235
    v_cvt_pk_bf16_f32 v214, v236, v237
    v_cvt_pk_bf16_f32 v215, v238, v239
    v_pk_mul_f32 v[224:225], v[144:145], v[176:177]
    v_pk_mul_f32 v[226:227], v[146:147], v[178:179]
    v_pk_mul_f32 v[228:229], v[148:149], v[180:181]
    v_pk_mul_f32 v[230:231], v[150:151], v[182:183]
    v_pk_mul_f32 v[232:233], v[152:153], v[184:185]
    v_pk_mul_f32 v[234:235], v[154:155], v[186:187]
    v_pk_mul_f32 v[236:237], v[156:157], v[188:189]
    v_pk_mul_f32 v[238:239], v[158:159], v[190:191]
    v_cvt_pk_bf16_f32 v96, v224, v225
    v_cvt_pk_bf16_f32 v97, v226, v227
    v_cvt_pk_bf16_f32 v98, v228, v229
    v_cvt_pk_bf16_f32 v99, v230, v231
    v_cvt_pk_bf16_f32 v100, v232, v233
    v_cvt_pk_bf16_f32 v101, v234, v235
    v_cvt_pk_bf16_f32 v102, v236, v237
    v_cvt_pk_bf16_f32 v103, v238, v239
    v_mfma_f32_16x16x32_bf16 v[192:195], v[96:99], v[208:211], 0
    v_mfma_f32_16x16x32_bf16 v[196:199], v[96:99], v[212:215], 0
    v_mfma_f32_16x16x32_bf16 v[200:203], v[100:103], v[208:211], 0
    v_mfma_f32_16x16x32_bf16 v[204:207], v[100:103], v[212:215], 0
    s_mov_b32 exec_lo, 0xff00ff00
    s_mov_b32 exec_hi, 0x00000000
    s_nop 2
    v_add_f32 v80, v80, v192
    v_add_f32 v84, v84, v196
    v_add_f32 v88, v88, v200
    v_add_f32 v92, v92, v204
    s_mov_b32 exec_lo, 0xff00ff00
    s_mov_b32 exec_hi, 0x00000000
    v_add_f32 v81, v81, v193
    v_add_f32 v85, v85, v197
    v_add_f32 v89, v89, v201
    v_add_f32 v93, v93, v205
    s_mov_b32 exec_lo, 0xff00ff00
    s_mov_b32 exec_hi, 0x00000000
    v_add_f32 v82, v82, v194
    v_add_f32 v86, v86, v198
    v_add_f32 v90, v90, v202
    v_add_f32 v94, v94, v206
    s_mov_b32 exec_lo, 0xff00ff00
    s_mov_b32 exec_hi, 0x00000000
    v_add_f32 v83, v83, v195
    v_add_f32 v87, v87, v199
    v_add_f32 v91, v91, v203
    v_add_f32 v95, v95, v207
    s_mov_b64 exec, -1
    v_mov_b32_dpp v136, v128 row_mirror row_mask:0xf bank_mask:0xf
    v_mov_b32_dpp v137, v129 row_mirror row_mask:0xf bank_mask:0xf
    v_mov_b32_dpp v138, v130 row_mirror row_mask:0xf bank_mask:0xf
    v_mov_b32_dpp v139, v131 row_mirror row_mask:0xf bank_mask:0xf
    v_mov_b32_dpp v140, v132 row_mirror row_mask:0xf bank_mask:0xf
    v_mov_b32_dpp v141, v133 row_mirror row_mask:0xf bank_mask:0xf
    v_mov_b32_dpp v142, v134 row_mirror row_mask:0xf bank_mask:0xf
    v_mov_b32_dpp v143, v135 row_mirror row_mask:0xf bank_mask:0xf
    s_mov_b32 exec_lo, 0xff00ff00
    s_mov_b32 exec_hi, 0xff00ff00
    v_pk_mul_f32 v[48:49], v[48:49], v[136:137]
    v_pk_mul_f32 v[50:51], v[50:51], v[138:139]
    v_pk_mul_f32 v[52:53], v[52:53], v[140:141]
    v_pk_mul_f32 v[54:55], v[54:55], v[142:143]
    v_pk_mul_f32 v[56:57], v[56:57], v[136:137]
    v_pk_mul_f32 v[58:59], v[58:59], v[138:139]
    v_pk_mul_f32 v[60:61], v[60:61], v[140:141]
    v_pk_mul_f32 v[62:63], v[62:63], v[142:143]
    s_mov_b32 exec_lo, 0x00ff00ff
    s_mov_b32 exec_hi, 0x00ff00ff
    v_pk_mul_f32 v[176:177], v[176:177], v[136:137]
    v_pk_mul_f32 v[178:179], v[178:179], v[138:139]
    v_pk_mul_f32 v[180:181], v[180:181], v[140:141]
    v_pk_mul_f32 v[182:183], v[182:183], v[142:143]
    v_pk_mul_f32 v[184:185], v[184:185], v[136:137]
    v_pk_mul_f32 v[186:187], v[186:187], v[138:139]
    v_pk_mul_f32 v[188:189], v[188:189], v[140:141]
    v_pk_mul_f32 v[190:191], v[190:191], v[142:143]
    s_mov_b64 exec, -1
    v_pk_mul_f32 v[128:129], v[128:129], v[136:137]
    v_pk_mul_f32 v[130:131], v[130:131], v[138:139]
    v_pk_mul_f32 v[132:133], v[132:133], v[140:141]
    v_pk_mul_f32 v[134:135], v[134:135], v[142:143]
    v_pk_mul_f32 v[224:225], v[144:145], v[176:177]
    v_pk_mul_f32 v[226:227], v[146:147], v[178:179]
    v_pk_mul_f32 v[228:229], v[148:149], v[180:181]
    v_pk_mul_f32 v[230:231], v[150:151], v[182:183]
    v_pk_mul_f32 v[232:233], v[152:153], v[184:185]
    v_pk_mul_f32 v[234:235], v[154:155], v[186:187]
    v_pk_mul_f32 v[236:237], v[156:157], v[188:189]
    v_pk_mul_f32 v[238:239], v[158:159], v[190:191]
    v_cvt_pk_bf16_f32 v96, v224, v225
    v_cvt_pk_bf16_f32 v97, v226, v227
    v_cvt_pk_bf16_f32 v98, v228, v229
    v_cvt_pk_bf16_f32 v99, v230, v231
    v_cvt_pk_bf16_f32 v100, v232, v233
    v_cvt_pk_bf16_f32 v101, v234, v235
    v_cvt_pk_bf16_f32 v102, v236, v237
    v_cvt_pk_bf16_f32 v103, v238, v239
    ds_write_b64 v8, v[96:97] offset:4096
    ds_write_b64 v9, v[98:99] offset:4096
    ds_write_b64 v9, v[100:101] offset:4352
    ds_write_b64 v8, v[102:103] offset:4352
    s_mov_b32 exec_lo, 0x80008000
    s_mov_b32 exec_hi, 0x80008000
    ds_write_b128 v5, v[56:59] offset:64
    ds_write_b128 v5, v[60:63] offset:80
    s_mov_b64 exec, -1
    buffer_load_dwordx4 v[224:227], v104, s[44:47], s6 offen offset:192
    buffer_load_dwordx4 v[228:231], v104, s[44:47], s6 offen offset:448
    buffer_load_dwordx4 v[232:235], v104, s[36:39], s6 offen offset:192
    buffer_load_dwordx4 v[236:239], v104, s[36:39], s6 offen offset:448
    buffer_load_dwordx4 v[208:211], v104, s[32:35], s6 offen offset:192
    buffer_load_dwordx4 v[212:215], v104, s[32:35], s6 offen offset:448
    s_waitcnt vmcnt(0)
    v_lshlrev_b32 v112, 16, v224
    v_and_b32 v113, 0xffff0000, v224
    v_lshlrev_b32 v114, 16, v225
    v_and_b32 v115, 0xffff0000, v225
    v_lshlrev_b32 v116, 16, v226
    v_and_b32 v117, 0xffff0000, v226
    v_lshlrev_b32 v118, 16, v227
    v_and_b32 v119, 0xffff0000, v227
    v_lshlrev_b32 v120, 16, v228
    v_and_b32 v121, 0xffff0000, v228
    v_lshlrev_b32 v122, 16, v229
    v_and_b32 v123, 0xffff0000, v229
    v_lshlrev_b32 v124, 16, v230
    v_and_b32 v125, 0xffff0000, v230
    v_lshlrev_b32 v126, 16, v231
    v_and_b32 v127, 0xffff0000, v231
    v_lshlrev_b32 v144, 16, v232
    v_and_b32 v145, 0xffff0000, v232
    v_lshlrev_b32 v146, 16, v233
    v_and_b32 v147, 0xffff0000, v233
    v_lshlrev_b32 v148, 16, v234
    v_and_b32 v149, 0xffff0000, v234
    v_lshlrev_b32 v150, 16, v235
    v_and_b32 v151, 0xffff0000, v235
    v_lshlrev_b32 v152, 16, v236
    v_and_b32 v153, 0xffff0000, v236
    v_lshlrev_b32 v154, 16, v237
    v_and_b32 v155, 0xffff0000, v237
    v_lshlrev_b32 v156, 16, v238
    v_and_b32 v157, 0xffff0000, v238
    v_lshlrev_b32 v158, 16, v239
    v_and_b32 v159, 0xffff0000, v239
    v_lshlrev_b32 v160, 16, v208
    v_and_b32 v161, 0xffff0000, v208
    v_lshlrev_b32 v162, 16, v209
    v_and_b32 v163, 0xffff0000, v209
    v_lshlrev_b32 v164, 16, v210
    v_and_b32 v165, 0xffff0000, v210
    v_lshlrev_b32 v166, 16, v211
    v_and_b32 v167, 0xffff0000, v211
    v_lshlrev_b32 v168, 16, v212
    v_and_b32 v169, 0xffff0000, v212
    v_lshlrev_b32 v170, 16, v213
    v_and_b32 v171, 0xffff0000, v213
    v_lshlrev_b32 v172, 16, v214
    v_and_b32 v173, 0xffff0000, v214
    v_lshlrev_b32 v174, 16, v215
    v_and_b32 v175, 0xffff0000, v215
    v_pk_mul_f32 v[144:145], v[144:145], s[12:13]
    v_pk_mul_f32 v[146:147], v[146:147], s[12:13]
    v_pk_mul_f32 v[148:149], v[148:149], s[12:13]
    v_pk_mul_f32 v[150:151], v[150:151], s[12:13]
    v_pk_mul_f32 v[152:153], v[152:153], s[12:13]
    v_pk_mul_f32 v[154:155], v[154:155], s[12:13]
    v_pk_mul_f32 v[156:157], v[156:157], s[12:13]
    v_pk_mul_f32 v[158:159], v[158:159], s[12:13]
    v_cvt_pk_bf16_f32 v232, v144, v145
    v_cvt_pk_bf16_f32 v233, v146, v147
    v_cvt_pk_bf16_f32 v234, v148, v149
    v_cvt_pk_bf16_f32 v235, v150, v151
    v_cvt_pk_bf16_f32 v236, v152, v153
    v_cvt_pk_bf16_f32 v237, v154, v155
    v_cvt_pk_bf16_f32 v238, v156, v157
    v_cvt_pk_bf16_f32 v239, v158, v159
    v_pk_mul_f32 v[112:113], v[112:113], s[8:9]
    v_pk_mul_f32 v[114:115], v[114:115], s[8:9]
    v_pk_mul_f32 v[116:117], v[116:117], s[8:9]
    v_pk_mul_f32 v[118:119], v[118:119], s[8:9]
    v_pk_mul_f32 v[120:121], v[120:121], s[8:9]
    v_pk_mul_f32 v[122:123], v[122:123], s[8:9]
    v_pk_mul_f32 v[124:125], v[124:125], s[8:9]
    v_pk_mul_f32 v[126:127], v[126:127], s[8:9]
    v_exp_f32 v112, v112
    v_exp_f32 v113, v113
    v_exp_f32 v114, v114
    v_exp_f32 v115, v115
    v_exp_f32 v116, v116
    v_exp_f32 v117, v117
    v_exp_f32 v118, v118
    v_exp_f32 v119, v119
    v_exp_f32 v120, v120
    v_exp_f32 v121, v121
    v_exp_f32 v122, v122
    v_exp_f32 v123, v123
    v_exp_f32 v124, v124
    v_exp_f32 v125, v125
    v_exp_f32 v126, v126
    v_exp_f32 v127, v127
    v_pk_add_f32 v[112:113], v[112:113], s[10:11]
    v_pk_add_f32 v[114:115], v[114:115], s[10:11]
    v_pk_add_f32 v[116:117], v[116:117], s[10:11]
    v_pk_add_f32 v[118:119], v[118:119], s[10:11]
    v_pk_add_f32 v[120:121], v[120:121], s[10:11]
    v_pk_add_f32 v[122:123], v[122:123], s[10:11]
    v_pk_add_f32 v[124:125], v[124:125], s[10:11]
    v_pk_add_f32 v[126:127], v[126:127], s[10:11]
    v_rcp_f32 v112, v112
    v_rcp_f32 v113, v113
    v_rcp_f32 v114, v114
    v_rcp_f32 v115, v115
    v_rcp_f32 v116, v116
    v_rcp_f32 v117, v117
    v_rcp_f32 v118, v118
    v_rcp_f32 v119, v119
    v_rcp_f32 v120, v120
    v_rcp_f32 v121, v121
    v_rcp_f32 v122, v122
    v_rcp_f32 v123, v123
    v_rcp_f32 v124, v124
    v_rcp_f32 v125, v125
    v_rcp_f32 v126, v126
    v_rcp_f32 v127, v127
    v_pk_mul_f32 v[136:137], v[168:169], v[120:121]
    v_pk_mul_f32 v[138:139], v[170:171], v[122:123]
    v_pk_mul_f32 v[140:141], v[172:173], v[124:125]
    v_pk_mul_f32 v[142:143], v[174:175], v[126:127]
    v_cvt_pk_bf16_f32 v96, v136, v137
    v_cvt_pk_bf16_f32 v97, v138, v139
    v_cvt_pk_bf16_f32 v98, v140, v141
    v_cvt_pk_bf16_f32 v99, v142, v143
    v_mfma_f32_16x16x32_bf16 v[192:195], v[232:235], v[208:211], 0
    v_mfma_f32_16x16x32_bf16 v[204:207], v[236:239], v[212:215], 0
    v_mfma_f32_16x16x32_bf16 v[196:199], v[232:235], v[96:99], 0
    s_mov_b32 exec_lo, 0x00100001
    s_mov_b32 exec_hi, 0x10000100
    s_nop 3
    v_add_f32 v80, v80, v192
    v_add_f32 v92, v92, v204
    v_add_f32 v84, v84, v196
    s_mov_b32 exec_lo, 0x00200002
    s_mov_b32 exec_hi, 0x20000200
    v_add_f32 v81, v81, v193
    v_add_f32 v93, v93, v205
    v_add_f32 v85, v85, v197
    s_mov_b32 exec_lo, 0x00400004
    s_mov_b32 exec_hi, 0x40000400
    v_add_f32 v82, v82, v194
    v_add_f32 v94, v94, v206
    v_add_f32 v86, v86, v198
    s_mov_b32 exec_lo, 0x00800008
    s_mov_b32 exec_hi, 0x80000800
    v_add_f32 v83, v83, v195
    v_add_f32 v95, v95, v207
    v_add_f32 v87, v87, v199
    s_mov_b64 exec, -1
    v_mov_b32 v64, v112
    v_mov_b32 v176, v120
    v_mov_b32 v184, 1.0
    v_mov_b32 v65, v113
    v_mov_b32 v177, v121
    v_mov_b32 v185, 1.0
    v_mov_b32 v66, v114
    v_mov_b32 v178, v122
    v_mov_b32 v186, 1.0
    v_mov_b32 v67, v115
    v_mov_b32 v179, v123
    v_mov_b32 v187, 1.0
    v_mov_b32 v68, v116
    v_mov_b32 v180, v124
    v_mov_b32 v188, 1.0
    v_mov_b32 v69, v117
    v_mov_b32 v181, v125
    v_mov_b32 v189, 1.0
    v_mov_b32 v70, v118
    v_mov_b32 v182, v126
    v_mov_b32 v190, 1.0
    v_mov_b32 v71, v119
    v_mov_b32 v183, v127
    v_mov_b32 v191, 1.0
    v_pk_mul_f32 v[72:73], v[112:113], v[120:121]
    v_pk_mul_f32 v[74:75], v[114:115], v[122:123]
    v_pk_mul_f32 v[76:77], v[116:117], v[124:125]
    v_pk_mul_f32 v[78:79], v[118:119], v[126:127]
    v_pk_mul_f32 v[128:129], v[112:113], v[120:121]
    v_pk_mul_f32 v[130:131], v[114:115], v[122:123]
    v_pk_mul_f32 v[132:133], v[116:117], v[124:125]
    v_pk_mul_f32 v[134:135], v[118:119], v[126:127]
    v_pk_mul_f32 v[224:225], v[160:161], v[64:65]
    v_pk_mul_f32 v[226:227], v[162:163], v[66:67]
    v_pk_mul_f32 v[228:229], v[164:165], v[68:69]
    v_pk_mul_f32 v[230:231], v[166:167], v[70:71]
    v_pk_mul_f32 v[232:233], v[168:169], v[72:73]
    v_pk_mul_f32 v[234:235], v[170:171], v[74:75]
    v_pk_mul_f32 v[236:237], v[172:173], v[76:77]
    v_pk_mul_f32 v[238:239], v[174:175], v[78:79]
    v_cvt_pk_bf16_f32 v208, v224, v225
    v_cvt_pk_bf16_f32 v209, v226, v227
    v_cvt_pk_bf16_f32 v210, v228, v229
    v_cvt_pk_bf16_f32 v211, v230, v231
    v_cvt_pk_bf16_f32 v212, v232, v233
    v_cvt_pk_bf16_f32 v213, v234, v235
    v_cvt_pk_bf16_f32 v214, v236, v237
    v_cvt_pk_bf16_f32 v215, v238, v239
    v_pk_mul_f32 v[224:225], v[144:145], v[176:177]
    v_pk_mul_f32 v[226:227], v[146:147], v[178:179]
    v_pk_mul_f32 v[228:229], v[148:149], v[180:181]
    v_pk_mul_f32 v[230:231], v[150:151], v[182:183]
    v_pk_mul_f32 v[232:233], v[152:153], v[184:185]
    v_pk_mul_f32 v[234:235], v[154:155], v[186:187]
    v_pk_mul_f32 v[236:237], v[156:157], v[188:189]
    v_pk_mul_f32 v[238:239], v[158:159], v[190:191]
    v_cvt_pk_bf16_f32 v96, v224, v225
    v_cvt_pk_bf16_f32 v97, v226, v227
    v_cvt_pk_bf16_f32 v98, v228, v229
    v_cvt_pk_bf16_f32 v99, v230, v231
    v_cvt_pk_bf16_f32 v100, v232, v233
    v_cvt_pk_bf16_f32 v101, v234, v235
    v_cvt_pk_bf16_f32 v102, v236, v237
    v_cvt_pk_bf16_f32 v103, v238, v239
    v_mfma_f32_16x16x32_bf16 v[192:195], v[96:99], v[208:211], 0
    v_mfma_f32_16x16x32_bf16 v[196:199], v[96:99], v[212:215], 0
    v_mfma_f32_16x16x32_bf16 v[200:203], v[100:103], v[208:211], 0
    v_mfma_f32_16x16x32_bf16 v[204:207], v[100:103], v[212:215], 0
    s_mov_b32 exec_lo, 0x00200002
    s_mov_b32 exec_hi, 0x20000200
    s_nop 2
    v_add_f32 v80, v80, v192
    v_add_f32 v84, v84, v196
    v_add_f32 v88, v88, v200
    v_add_f32 v92, v92, v204
    s_mov_b32 exec_lo, 0x00000000
    s_mov_b32 exec_hi, 0x00000000
    v_add_f32 v81, v81, v193
    v_add_f32 v85, v85, v197
    v_add_f32 v89, v89, v201
    v_add_f32 v93, v93, v205
    s_mov_b32 exec_lo, 0x00800008
    s_mov_b32 exec_hi, 0x80000800
    v_add_f32 v82, v82, v194
    v_add_f32 v86, v86, v198
    v_add_f32 v90, v90, v202
    v_add_f32 v94, v94, v206
    s_mov_b32 exec_lo, 0x00000000
    s_mov_b32 exec_hi, 0x00000000
    v_add_f32 v83, v83, v195
    v_add_f32 v87, v87, v199
    v_add_f32 v91, v91, v203
    v_add_f32 v95, v95, v207
    s_mov_b64 exec, -1
    v_mov_b32_dpp v136, v128 quad_perm:[1,0,3,2] row_mask:0xf bank_mask:0xf
    v_mov_b32_dpp v137, v129 quad_perm:[1,0,3,2] row_mask:0xf bank_mask:0xf
    v_mov_b32_dpp v138, v130 quad_perm:[1,0,3,2] row_mask:0xf bank_mask:0xf
    v_mov_b32_dpp v139, v131 quad_perm:[1,0,3,2] row_mask:0xf bank_mask:0xf
    v_mov_b32_dpp v140, v132 quad_perm:[1,0,3,2] row_mask:0xf bank_mask:0xf
    v_mov_b32_dpp v141, v133 quad_perm:[1,0,3,2] row_mask:0xf bank_mask:0xf
    v_mov_b32_dpp v142, v134 quad_perm:[1,0,3,2] row_mask:0xf bank_mask:0xf
    v_mov_b32_dpp v143, v135 quad_perm:[1,0,3,2] row_mask:0xf bank_mask:0xf
    s_mov_b32 exec_lo, 0xaaaaaaaa
    s_mov_b32 exec_hi, 0xaaaaaaaa
    v_pk_mul_f32 v[64:65], v[64:65], v[136:137]
    v_pk_mul_f32 v[66:67], v[66:67], v[138:139]
    v_pk_mul_f32 v[68:69], v[68:69], v[140:141]
    v_pk_mul_f32 v[70:71], v[70:71], v[142:143]
    v_pk_mul_f32 v[72:73], v[72:73], v[136:137]
    v_pk_mul_f32 v[74:75], v[74:75], v[138:139]
    v_pk_mul_f32 v[76:77], v[76:77], v[140:141]
    v_pk_mul_f32 v[78:79], v[78:79], v[142:143]
    s_mov_b32 exec_lo, 0x55555555
    s_mov_b32 exec_hi, 0x55555555
    v_pk_mul_f32 v[176:177], v[176:177], v[136:137]
    v_pk_mul_f32 v[178:179], v[178:179], v[138:139]
    v_pk_mul_f32 v[180:181], v[180:181], v[140:141]
    v_pk_mul_f32 v[182:183], v[182:183], v[142:143]
    v_pk_mul_f32 v[184:185], v[184:185], v[136:137]
    v_pk_mul_f32 v[186:187], v[186:187], v[138:139]
    v_pk_mul_f32 v[188:189], v[188:189], v[140:141]
    v_pk_mul_f32 v[190:191], v[190:191], v[142:143]
    s_mov_b64 exec, -1
    v_pk_mul_f32 v[128:129], v[128:129], v[136:137]
    v_pk_mul_f32 v[130:131], v[130:131], v[138:139]
    v_pk_mul_f32 v[132:133], v[132:133], v[140:141]
    v_pk_mul_f32 v[134:135], v[134:135], v[142:143]
    v_pk_mul_f32 v[224:225], v[160:161], v[64:65]
    v_pk_mul_f32 v[226:227], v[162:163], v[66:67]
    v_pk_mul_f32 v[228:229], v[164:165], v[68:69]
    v_pk_mul_f32 v[230:231], v[166:167], v[70:71]
    v_pk_mul_f32 v[232:233], v[168:169], v[72:73]
    v_pk_mul_f32 v[234:235], v[170:171], v[74:75]
    v_pk_mul_f32 v[236:237], v[172:173], v[76:77]
    v_pk_mul_f32 v[238:239], v[174:175], v[78:79]
    v_cvt_pk_bf16_f32 v208, v224, v225
    v_cvt_pk_bf16_f32 v209, v226, v227
    v_cvt_pk_bf16_f32 v210, v228, v229
    v_cvt_pk_bf16_f32 v211, v230, v231
    v_cvt_pk_bf16_f32 v212, v232, v233
    v_cvt_pk_bf16_f32 v213, v234, v235
    v_cvt_pk_bf16_f32 v214, v236, v237
    v_cvt_pk_bf16_f32 v215, v238, v239
    v_pk_mul_f32 v[224:225], v[144:145], v[176:177]
    v_pk_mul_f32 v[226:227], v[146:147], v[178:179]
    v_pk_mul_f32 v[228:229], v[148:149], v[180:181]
    v_pk_mul_f32 v[230:231], v[150:151], v[182:183]
    v_pk_mul_f32 v[232:233], v[152:153], v[184:185]
    v_pk_mul_f32 v[234:235], v[154:155], v[186:187]
    v_pk_mul_f32 v[236:237], v[156:157], v[188:189]
    v_pk_mul_f32 v[238:239], v[158:159], v[190:191]
    v_cvt_pk_bf16_f32 v96, v224, v225
    v_cvt_pk_bf16_f32 v97, v226, v227
    v_cvt_pk_bf16_f32 v98, v228, v229
    v_cvt_pk_bf16_f32 v99, v230, v231
    v_cvt_pk_bf16_f32 v100, v232, v233
    v_cvt_pk_bf16_f32 v101, v234, v235
    v_cvt_pk_bf16_f32 v102, v236, v237
    v_cvt_pk_bf16_f32 v103, v238, v239
    v_mfma_f32_16x16x32_bf16 v[192:195], v[96:99], v[208:211], 0
    v_mfma_f32_16x16x32_bf16 v[196:199], v[96:99], v[212:215], 0
    v_mfma_f32_16x16x32_bf16 v[200:203], v[100:103], v[208:211], 0
    v_mfma_f32_16x16x32_bf16 v[204:207], v[100:103], v[212:215], 0
    s_mov_b32 exec_lo, 0x00c0000c
    s_mov_b32 exec_hi, 0xc0000c00
    s_nop 2
    v_add_f32 v80, v80, v192
    v_add_f32 v84, v84, v196
    v_add_f32 v88, v88, v200
    v_add_f32 v92, v92, v204
    s_mov_b32 exec_lo, 0x00c0000c
    s_mov_b32 exec_hi, 0xc0000c00
    v_add_f32 v81, v81, v193
    v_add_f32 v85, v85, v197
    v_add_f32 v89, v89, v201
    v_add_f32 v93, v93, v205
    s_mov_b32 exec_lo, 0x00000000
    s_mov_b32 exec_hi, 0x00000000
    v_add_f32 v82, v82, v194
    v_add_f32 v86, v86, v198
    v_add_f32 v90, v90, v202
    v_add_f32 v94, v94, v206
    s_mov_b32 exec_lo, 0x00000000
    s_mov_b32 exec_hi, 0x00000000
    v_add_f32 v83, v83, v195
    v_add_f32 v87, v87, v199
    v_add_f32 v91, v91, v203
    v_add_f32 v95, v95, v207
    s_mov_b64 exec, -1
    v_mov_b32_dpp v136, v128 quad_perm:[2,3,0,1] row_mask:0xf bank_mask:0xf
    v_mov_b32_dpp v137, v129 quad_perm:[2,3,0,1] row_mask:0xf bank_mask:0xf
    v_mov_b32_dpp v138, v130 quad_perm:[2,3,0,1] row_mask:0xf bank_mask:0xf
    v_mov_b32_dpp v139, v131 quad_perm:[2,3,0,1] row_mask:0xf bank_mask:0xf
    v_mov_b32_dpp v140, v132 quad_perm:[2,3,0,1] row_mask:0xf bank_mask:0xf
    v_mov_b32_dpp v141, v133 quad_perm:[2,3,0,1] row_mask:0xf bank_mask:0xf
    v_mov_b32_dpp v142, v134 quad_perm:[2,3,0,1] row_mask:0xf bank_mask:0xf
    v_mov_b32_dpp v143, v135 quad_perm:[2,3,0,1] row_mask:0xf bank_mask:0xf
    s_mov_b32 exec_lo, 0xcccccccc
    s_mov_b32 exec_hi, 0xcccccccc
    v_pk_mul_f32 v[64:65], v[64:65], v[136:137]
    v_pk_mul_f32 v[66:67], v[66:67], v[138:139]
    v_pk_mul_f32 v[68:69], v[68:69], v[140:141]
    v_pk_mul_f32 v[70:71], v[70:71], v[142:143]
    v_pk_mul_f32 v[72:73], v[72:73], v[136:137]
    v_pk_mul_f32 v[74:75], v[74:75], v[138:139]
    v_pk_mul_f32 v[76:77], v[76:77], v[140:141]
    v_pk_mul_f32 v[78:79], v[78:79], v[142:143]
    s_mov_b32 exec_lo, 0x33333333
    s_mov_b32 exec_hi, 0x33333333
    v_pk_mul_f32 v[176:177], v[176:177], v[136:137]
    v_pk_mul_f32 v[178:179], v[178:179], v[138:139]
    v_pk_mul_f32 v[180:181], v[180:181], v[140:141]
    v_pk_mul_f32 v[182:183], v[182:183], v[142:143]
    v_pk_mul_f32 v[184:185], v[184:185], v[136:137]
    v_pk_mul_f32 v[186:187], v[186:187], v[138:139]
    v_pk_mul_f32 v[188:189], v[188:189], v[140:141]
    v_pk_mul_f32 v[190:191], v[190:191], v[142:143]
    s_mov_b64 exec, -1
    v_pk_mul_f32 v[128:129], v[128:129], v[136:137]
    v_pk_mul_f32 v[130:131], v[130:131], v[138:139]
    v_pk_mul_f32 v[132:133], v[132:133], v[140:141]
    v_pk_mul_f32 v[134:135], v[134:135], v[142:143]
    v_pk_mul_f32 v[224:225], v[160:161], v[64:65]
    v_pk_mul_f32 v[226:227], v[162:163], v[66:67]
    v_pk_mul_f32 v[228:229], v[164:165], v[68:69]
    v_pk_mul_f32 v[230:231], v[166:167], v[70:71]
    v_pk_mul_f32 v[232:233], v[168:169], v[72:73]
    v_pk_mul_f32 v[234:235], v[170:171], v[74:75]
    v_pk_mul_f32 v[236:237], v[172:173], v[76:77]
    v_pk_mul_f32 v[238:239], v[174:175], v[78:79]
    v_cvt_pk_bf16_f32 v208, v224, v225
    v_cvt_pk_bf16_f32 v209, v226, v227
    v_cvt_pk_bf16_f32 v210, v228, v229
    v_cvt_pk_bf16_f32 v211, v230, v231
    v_cvt_pk_bf16_f32 v212, v232, v233
    v_cvt_pk_bf16_f32 v213, v234, v235
    v_cvt_pk_bf16_f32 v214, v236, v237
    v_cvt_pk_bf16_f32 v215, v238, v239
    v_pk_mul_f32 v[224:225], v[144:145], v[176:177]
    v_pk_mul_f32 v[226:227], v[146:147], v[178:179]
    v_pk_mul_f32 v[228:229], v[148:149], v[180:181]
    v_pk_mul_f32 v[230:231], v[150:151], v[182:183]
    v_pk_mul_f32 v[232:233], v[152:153], v[184:185]
    v_pk_mul_f32 v[234:235], v[154:155], v[186:187]
    v_pk_mul_f32 v[236:237], v[156:157], v[188:189]
    v_pk_mul_f32 v[238:239], v[158:159], v[190:191]
    v_cvt_pk_bf16_f32 v96, v224, v225
    v_cvt_pk_bf16_f32 v97, v226, v227
    v_cvt_pk_bf16_f32 v98, v228, v229
    v_cvt_pk_bf16_f32 v99, v230, v231
    v_cvt_pk_bf16_f32 v100, v232, v233
    v_cvt_pk_bf16_f32 v101, v234, v235
    v_cvt_pk_bf16_f32 v102, v236, v237
    v_cvt_pk_bf16_f32 v103, v238, v239
    v_mfma_f32_16x16x32_bf16 v[192:195], v[96:99], v[208:211], 0
    v_mfma_f32_16x16x32_bf16 v[196:199], v[96:99], v[212:215], 0
    v_mfma_f32_16x16x32_bf16 v[200:203], v[100:103], v[208:211], 0
    v_mfma_f32_16x16x32_bf16 v[204:207], v[100:103], v[212:215], 0
    s_mov_b32 exec_lo, 0x000000f0
    s_mov_b32 exec_hi, 0x0000f000
    s_nop 2
    v_add_f32 v80, v80, v192
    v_add_f32 v84, v84, v196
    v_add_f32 v88, v88, v200
    v_add_f32 v92, v92, v204
    s_mov_b32 exec_lo, 0x000000f0
    s_mov_b32 exec_hi, 0x0000f000
    v_add_f32 v81, v81, v193
    v_add_f32 v85, v85, v197
    v_add_f32 v89, v89, v201
    v_add_f32 v93, v93, v205
    s_mov_b32 exec_lo, 0x000000f0
    s_mov_b32 exec_hi, 0x0000f000
    v_add_f32 v82, v82, v194
    v_add_f32 v86, v86, v198
    v_add_f32 v90, v90, v202
    v_add_f32 v94, v94, v206
    s_mov_b32 exec_lo, 0x000000f0
    s_mov_b32 exec_hi, 0x0000f000
    v_add_f32 v83, v83, v195
    v_add_f32 v87, v87, v199
    v_add_f32 v91, v91, v203
    v_add_f32 v95, v95, v207
    s_mov_b64 exec, -1
    v_mov_b32_dpp v136, v128 row_half_mirror row_mask:0xf bank_mask:0xf
    v_mov_b32_dpp v137, v129 row_half_mirror row_mask:0xf bank_mask:0xf
    v_mov_b32_dpp v138, v130 row_half_mirror row_mask:0xf bank_mask:0xf
    v_mov_b32_dpp v139, v131 row_half_mirror row_mask:0xf bank_mask:0xf
    v_mov_b32_dpp v140, v132 row_half_mirror row_mask:0xf bank_mask:0xf
    v_mov_b32_dpp v141, v133 row_half_mirror row_mask:0xf bank_mask:0xf
    v_mov_b32_dpp v142, v134 row_half_mirror row_mask:0xf bank_mask:0xf
    v_mov_b32_dpp v143, v135 row_half_mirror row_mask:0xf bank_mask:0xf
    s_mov_b32 exec_lo, 0xf0f0f0f0
    s_mov_b32 exec_hi, 0xf0f0f0f0
    v_pk_mul_f32 v[64:65], v[64:65], v[136:137]
    v_pk_mul_f32 v[66:67], v[66:67], v[138:139]
    v_pk_mul_f32 v[68:69], v[68:69], v[140:141]
    v_pk_mul_f32 v[70:71], v[70:71], v[142:143]
    v_pk_mul_f32 v[72:73], v[72:73], v[136:137]
    v_pk_mul_f32 v[74:75], v[74:75], v[138:139]
    v_pk_mul_f32 v[76:77], v[76:77], v[140:141]
    v_pk_mul_f32 v[78:79], v[78:79], v[142:143]
    s_mov_b32 exec_lo, 0x0f0f0f0f
    s_mov_b32 exec_hi, 0x0f0f0f0f
    v_pk_mul_f32 v[176:177], v[176:177], v[136:137]
    v_pk_mul_f32 v[178:179], v[178:179], v[138:139]
    v_pk_mul_f32 v[180:181], v[180:181], v[140:141]
    v_pk_mul_f32 v[182:183], v[182:183], v[142:143]
    v_pk_mul_f32 v[184:185], v[184:185], v[136:137]
    v_pk_mul_f32 v[186:187], v[186:187], v[138:139]
    v_pk_mul_f32 v[188:189], v[188:189], v[140:141]
    v_pk_mul_f32 v[190:191], v[190:191], v[142:143]
    s_mov_b64 exec, -1
    v_pk_mul_f32 v[128:129], v[128:129], v[136:137]
    v_pk_mul_f32 v[130:131], v[130:131], v[138:139]
    v_pk_mul_f32 v[132:133], v[132:133], v[140:141]
    v_pk_mul_f32 v[134:135], v[134:135], v[142:143]
    v_pk_mul_f32 v[224:225], v[160:161], v[64:65]
    v_pk_mul_f32 v[226:227], v[162:163], v[66:67]
    v_pk_mul_f32 v[228:229], v[164:165], v[68:69]
    v_pk_mul_f32 v[230:231], v[166:167], v[70:71]
    v_pk_mul_f32 v[232:233], v[168:169], v[72:73]
    v_pk_mul_f32 v[234:235], v[170:171], v[74:75]
    v_pk_mul_f32 v[236:237], v[172:173], v[76:77]
    v_pk_mul_f32 v[238:239], v[174:175], v[78:79]
    v_cvt_pk_bf16_f32 v208, v224, v225
    v_cvt_pk_bf16_f32 v209, v226, v227
    v_cvt_pk_bf16_f32 v210, v228, v229
    v_cvt_pk_bf16_f32 v211, v230, v231
    v_cvt_pk_bf16_f32 v212, v232, v233
    v_cvt_pk_bf16_f32 v213, v234, v235
    v_cvt_pk_bf16_f32 v214, v236, v237
    v_cvt_pk_bf16_f32 v215, v238, v239
    v_pk_mul_f32 v[224:225], v[144:145], v[176:177]
    v_pk_mul_f32 v[226:227], v[146:147], v[178:179]
    v_pk_mul_f32 v[228:229], v[148:149], v[180:181]
    v_pk_mul_f32 v[230:231], v[150:151], v[182:183]
    v_pk_mul_f32 v[232:233], v[152:153], v[184:185]
    v_pk_mul_f32 v[234:235], v[154:155], v[186:187]
    v_pk_mul_f32 v[236:237], v[156:157], v[188:189]
    v_pk_mul_f32 v[238:239], v[158:159], v[190:191]
    v_cvt_pk_bf16_f32 v96, v224, v225
    v_cvt_pk_bf16_f32 v97, v226, v227
    v_cvt_pk_bf16_f32 v98, v228, v229
    v_cvt_pk_bf16_f32 v99, v230, v231
    v_cvt_pk_bf16_f32 v100, v232, v233
    v_cvt_pk_bf16_f32 v101, v234, v235
    v_cvt_pk_bf16_f32 v102, v236, v237
    v_cvt_pk_bf16_f32 v103, v238, v239
    v_mfma_f32_16x16x32_bf16 v[192:195], v[96:99], v[208:211], 0
    v_mfma_f32_16x16x32_bf16 v[196:199], v[96:99], v[212:215], 0
    v_mfma_f32_16x16x32_bf16 v[200:203], v[100:103], v[208:211], 0
    v_mfma_f32_16x16x32_bf16 v[204:207], v[100:103], v[212:215], 0
    s_mov_b32 exec_lo, 0xff00ff00
    s_mov_b32 exec_hi, 0x00000000
    s_nop 2
    v_add_f32 v80, v80, v192
    v_add_f32 v84, v84, v196
    v_add_f32 v88, v88, v200
    v_add_f32 v92, v92, v204
    s_mov_b32 exec_lo, 0xff00ff00
    s_mov_b32 exec_hi, 0x00000000
    v_add_f32 v81, v81, v193
    v_add_f32 v85, v85, v197
    v_add_f32 v89, v89, v201
    v_add_f32 v93, v93, v205
    s_mov_b32 exec_lo, 0xff00ff00
    s_mov_b32 exec_hi, 0x00000000
    v_add_f32 v82, v82, v194
    v_add_f32 v86, v86, v198
    v_add_f32 v90, v90, v202
    v_add_f32 v94, v94, v206
    s_mov_b32 exec_lo, 0xff00ff00
    s_mov_b32 exec_hi, 0x00000000
    v_add_f32 v83, v83, v195
    v_add_f32 v87, v87, v199
    v_add_f32 v91, v91, v203
    v_add_f32 v95, v95, v207
    s_mov_b64 exec, -1
    v_mov_b32_dpp v136, v128 row_mirror row_mask:0xf bank_mask:0xf
    v_mov_b32_dpp v137, v129 row_mirror row_mask:0xf bank_mask:0xf
    v_mov_b32_dpp v138, v130 row_mirror row_mask:0xf bank_mask:0xf
    v_mov_b32_dpp v139, v131 row_mirror row_mask:0xf bank_mask:0xf
    v_mov_b32_dpp v140, v132 row_mirror row_mask:0xf bank_mask:0xf
    v_mov_b32_dpp v141, v133 row_mirror row_mask:0xf bank_mask:0xf
    v_mov_b32_dpp v142, v134 row_mirror row_mask:0xf bank_mask:0xf
    v_mov_b32_dpp v143, v135 row_mirror row_mask:0xf bank_mask:0xf
    s_mov_b32 exec_lo, 0xff00ff00
    s_mov_b32 exec_hi, 0xff00ff00
    v_pk_mul_f32 v[64:65], v[64:65], v[136:137]
    v_pk_mul_f32 v[66:67], v[66:67], v[138:139]
    v_pk_mul_f32 v[68:69], v[68:69], v[140:141]
    v_pk_mul_f32 v[70:71], v[70:71], v[142:143]
    v_pk_mul_f32 v[72:73], v[72:73], v[136:137]
    v_pk_mul_f32 v[74:75], v[74:75], v[138:139]
    v_pk_mul_f32 v[76:77], v[76:77], v[140:141]
    v_pk_mul_f32 v[78:79], v[78:79], v[142:143]
    s_mov_b32 exec_lo, 0x00ff00ff
    s_mov_b32 exec_hi, 0x00ff00ff
    v_pk_mul_f32 v[176:177], v[176:177], v[136:137]
    v_pk_mul_f32 v[178:179], v[178:179], v[138:139]
    v_pk_mul_f32 v[180:181], v[180:181], v[140:141]
    v_pk_mul_f32 v[182:183], v[182:183], v[142:143]
    v_pk_mul_f32 v[184:185], v[184:185], v[136:137]
    v_pk_mul_f32 v[186:187], v[186:187], v[138:139]
    v_pk_mul_f32 v[188:189], v[188:189], v[140:141]
    v_pk_mul_f32 v[190:191], v[190:191], v[142:143]
    s_mov_b64 exec, -1
    v_pk_mul_f32 v[128:129], v[128:129], v[136:137]
    v_pk_mul_f32 v[130:131], v[130:131], v[138:139]
    v_pk_mul_f32 v[132:133], v[132:133], v[140:141]
    v_pk_mul_f32 v[134:135], v[134:135], v[142:143]
    v_pk_mul_f32 v[224:225], v[144:145], v[176:177]
    v_pk_mul_f32 v[226:227], v[146:147], v[178:179]
    v_pk_mul_f32 v[228:229], v[148:149], v[180:181]
    v_pk_mul_f32 v[230:231], v[150:151], v[182:183]
    v_pk_mul_f32 v[232:233], v[152:153], v[184:185]
    v_pk_mul_f32 v[234:235], v[154:155], v[186:187]
    v_pk_mul_f32 v[236:237], v[156:157], v[188:189]
    v_pk_mul_f32 v[238:239], v[158:159], v[190:191]
    v_cvt_pk_bf16_f32 v96, v224, v225
    v_cvt_pk_bf16_f32 v97, v226, v227
    v_cvt_pk_bf16_f32 v98, v228, v229
    v_cvt_pk_bf16_f32 v99, v230, v231
    v_cvt_pk_bf16_f32 v100, v232, v233
    v_cvt_pk_bf16_f32 v101, v234, v235
    v_cvt_pk_bf16_f32 v102, v236, v237
    v_cvt_pk_bf16_f32 v103, v238, v239
    ds_write_b64 v10, v[96:97] offset:4096
    ds_write_b64 v11, v[98:99] offset:4096
    ds_write_b64 v11, v[100:101] offset:4352
    ds_write_b64 v10, v[102:103] offset:4352
    s_mov_b32 exec_lo, 0x80008000
    s_mov_b32 exec_hi, 0x80008000
    ds_write_b128 v5, v[72:75] offset:96
    s_waitcnt lgkmcnt(14)
    ds_write_b128 v5, v[76:79] offset:112
    s_mov_b64 exec, -1
    s_waitcnt lgkmcnt(14)
    ds_read_b64_tr_b16 v[224:225], v240 offset:4096
    s_waitcnt lgkmcnt(14)
    ds_read_b64_tr_b16 v[226:227], v241 offset:4608
    s_waitcnt lgkmcnt(14)
    ds_read_b64_tr_b16 v[228:229], v241 offset:4096
    s_waitcnt lgkmcnt(14)
    ds_read_b64_tr_b16 v[230:231], v240 offset:4608
    s_waitcnt lgkmcnt(14)
    ds_read_b64_tr_b16 v[232:233], v242 offset:4096
    s_waitcnt lgkmcnt(14)
    ds_read_b64_tr_b16 v[234:235], v243 offset:4608
    s_waitcnt lgkmcnt(14)
    ds_read_b64_tr_b16 v[236:237], v243 offset:4096
    s_waitcnt lgkmcnt(14)
    ds_read_b64_tr_b16 v[238:239], v242 offset:4608
    s_waitcnt lgkmcnt(0)
    ds_write_b128 v244, v[224:227] offset:4096
    ds_write_b128 v244, v[228:231] offset:5120
    ds_write_b128 v244, v[232:235] offset:6144
    ds_write_b128 v244, v[236:239] offset:7168
    v_cvt_pk_bf16_f32 v192, v80, v88
    v_cvt_pk_bf16_f32 v193, v81, v89
    v_cvt_pk_bf16_f32 v194, v82, v90
    v_cvt_pk_bf16_f32 v195, v83, v91
    ds_write_b128 v105, v[192:195] offset:0
    v_cvt_pk_bf16_f32 v196, v84, v92
    v_cvt_pk_bf16_f32 v197, v85, v93
    v_cvt_pk_bf16_f32 v198, v86, v94
    v_cvt_pk_bf16_f32 v199, v87, v95
    ds_write_b128 v105, v[196:199] offset:1024
    s_waitcnt vmcnt(0) lgkmcnt(0)
    s_nop 12
    s_branch L_fbA_ret
    s_nop 12
L_fullA:
    s_waitcnt lgkmcnt(0)
    ds_read_b128 v[192:195], v7 offset:0
    ds_read_b128 v[196:199], v7 offset:1024
    ds_read_b128 v[200:203], v7 offset:2048
    ds_read_b128 v[204:207], v7 offset:3072
    ds_read_b128 v[208:211], v7 offset:4096
    ds_read_b128 v[212:215], v7 offset:5120
    ds_read_b128 v[216:219], v7 offset:6144
    ds_read_b128 v[220:223], v7 offset:7168
    s_waitcnt lgkmcnt(7)
    v_mfma_f32_16x16x32_bf16 v[144:147], v[192:195], v[112:115], 0
    ds_read_b128 v[192:195], v7 offset:8192
    s_waitcnt lgkmcnt(7)
    v_mfma_f32_16x16x32_bf16 v[148:151], v[196:199], v[112:115], 0
    ds_read_b128 v[196:199], v7 offset:9216
    s_waitcnt lgkmcnt(7)
    v_mfma_f32_16x16x32_bf16 v[152:155], v[200:203], v[112:115], 0
    ds_read_b128 v[200:203], v7 offset:10240
    s_nop 0
    v_mul_f32_dpp v144, v178, v144 row_newbcast:0 row_mask:0xf bank_mask:0xf
    v_mul_f32_dpp v145, v179, v145 row_newbcast:0 row_mask:0xf bank_mask:0xf
    v_mul_f32_dpp v146, v178, v146 row_newbcast:1 row_mask:0xf bank_mask:0xf
    v_mul_f32_dpp v147, v179, v147 row_newbcast:1 row_mask:0xf bank_mask:0xf
    s_waitcnt lgkmcnt(7)
    v_mfma_f32_16x16x32_bf16 v[156:159], v[204:207], v[112:115], 0
    ds_read_b128 v[204:207], v7 offset:11264
    v_mul_f32_dpp v148, v178, v148 row_newbcast:2 row_mask:0xf bank_mask:0xf
    v_mul_f32_dpp v149, v179, v149 row_newbcast:2 row_mask:0xf bank_mask:0xf
    v_mul_f32_dpp v150, v178, v150 row_newbcast:3 row_mask:0xf bank_mask:0xf
    v_mul_f32_dpp v151, v179, v151 row_newbcast:3 row_mask:0xf bank_mask:0xf
    s_waitcnt lgkmcnt(7)
    v_mfma_f32_16x16x32_bf16 v[160:163], v[208:211], v[112:115], 0
    ds_read_b128 v[208:211], v7 offset:12288
    v_mul_f32_dpp v152, v178, v152 row_newbcast:4 row_mask:0xf bank_mask:0xf
    v_mul_f32_dpp v153, v179, v153 row_newbcast:4 row_mask:0xf bank_mask:0xf
    v_mul_f32_dpp v154, v178, v154 row_newbcast:5 row_mask:0xf bank_mask:0xf
    v_mul_f32_dpp v155, v179, v155 row_newbcast:5 row_mask:0xf bank_mask:0xf
    s_waitcnt lgkmcnt(7)
    v_mfma_f32_16x16x32_bf16 v[164:167], v[212:215], v[112:115], 0
    ds_read_b128 v[212:215], v7 offset:13312
    v_mul_f32_dpp v156, v178, v156 row_newbcast:6 row_mask:0xf bank_mask:0xf
    v_mul_f32_dpp v157, v179, v157 row_newbcast:6 row_mask:0xf bank_mask:0xf
    v_mul_f32_dpp v158, v178, v158 row_newbcast:7 row_mask:0xf bank_mask:0xf
    v_mul_f32_dpp v159, v179, v159 row_newbcast:7 row_mask:0xf bank_mask:0xf
    s_waitcnt lgkmcnt(7)
    v_mfma_f32_16x16x32_bf16 v[168:171], v[216:219], v[112:115], 0
    ds_read_b128 v[216:219], v7 offset:14336
    v_mul_f32_dpp v160, v178, v160 row_newbcast:8 row_mask:0xf bank_mask:0xf
    v_mul_f32_dpp v161, v179, v161 row_newbcast:8 row_mask:0xf bank_mask:0xf
    v_mul_f32_dpp v162, v178, v162 row_newbcast:9 row_mask:0xf bank_mask:0xf
    v_mul_f32_dpp v163, v179, v163 row_newbcast:9 row_mask:0xf bank_mask:0xf
    s_waitcnt lgkmcnt(7)
    v_mfma_f32_16x16x32_bf16 v[172:175], v[220:223], v[112:115], 0
    ds_read_b128 v[220:223], v7 offset:15360
    v_mul_f32_dpp v164, v178, v164 row_newbcast:10 row_mask:0xf bank_mask:0xf
    v_mul_f32_dpp v165, v179, v165 row_newbcast:10 row_mask:0xf bank_mask:0xf
    v_mul_f32_dpp v166, v178, v166 row_newbcast:11 row_mask:0xf bank_mask:0xf
    v_mul_f32_dpp v167, v179, v167 row_newbcast:11 row_mask:0xf bank_mask:0xf
    v_mul_f32_dpp v168, v178, v168 row_newbcast:12 row_mask:0xf bank_mask:0xf
    v_mul_f32_dpp v169, v179, v169 row_newbcast:12 row_mask:0xf bank_mask:0xf
    v_mul_f32_dpp v170, v178, v170 row_newbcast:13 row_mask:0xf bank_mask:0xf
    v_mul_f32_dpp v171, v179, v171 row_newbcast:13 row_mask:0xf bank_mask:0xf
    v_mul_f32_dpp v172, v178, v172 row_newbcast:14 row_mask:0xf bank_mask:0xf
    v_mul_f32_dpp v173, v179, v173 row_newbcast:14 row_mask:0xf bank_mask:0xf
    v_mul_f32_dpp v174, v178, v174 row_newbcast:15 row_mask:0xf bank_mask:0xf
    v_mul_f32_dpp v175, v179, v175 row_newbcast:15 row_mask:0xf bank_mask:0xf
    s_waitcnt lgkmcnt(7)
    v_mfma_f32_16x16x32_bf16 v[144:147], v[192:195], v[116:119], v[144:147]
    ds_read_b128 v[192:195], v7 offset:16384
    s_waitcnt lgkmcnt(7)
    v_mfma_f32_16x16x32_bf16 v[148:151], v[196:199], v[116:119], v[148:151]
    ds_read_b128 v[196:199], v7 offset:17408
    s_waitcnt lgkmcnt(7)
    v_mfma_f32_16x16x32_bf16 v[152:155], v[200:203], v[116:119], v[152:155]
    ds_read_b128 v[200:203], v7 offset:18432
    s_nop 0
    v_mul_f32_dpp v144, v180, v144 row_newbcast:0 row_mask:0xf bank_mask:0xf
    v_mul_f32_dpp v145, v181, v145 row_newbcast:0 row_mask:0xf bank_mask:0xf
    v_mul_f32_dpp v146, v180, v146 row_newbcast:1 row_mask:0xf bank_mask:0xf
    v_mul_f32_dpp v147, v181, v147 row_newbcast:1 row_mask:0xf bank_mask:0xf
    s_waitcnt lgkmcnt(7)
    v_mfma_f32_16x16x32_bf16 v[156:159], v[204:207], v[116:119], v[156:159]
    ds_read_b128 v[204:207], v7 offset:19456
    v_mul_f32_dpp v148, v180, v148 row_newbcast:2 row_mask:0xf bank_mask:0xf
    v_mul_f32_dpp v149, v181, v149 row_newbcast:2 row_mask:0xf bank_mask:0xf
    v_mul_f32_dpp v150, v180, v150 row_newbcast:3 row_mask:0xf bank_mask:0xf
    v_mul_f32_dpp v151, v181, v151 row_newbcast:3 row_mask:0xf bank_mask:0xf
    s_waitcnt lgkmcnt(7)
    v_mfma_f32_16x16x32_bf16 v[160:163], v[208:211], v[116:119], v[160:163]
    ds_read_b128 v[208:211], v7 offset:20480
    v_mul_f32_dpp v152, v180, v152 row_newbcast:4 row_mask:0xf bank_mask:0xf
    v_mul_f32_dpp v153, v181, v153 row_newbcast:4 row_mask:0xf bank_mask:0xf
    v_mul_f32_dpp v154, v180, v154 row_newbcast:5 row_mask:0xf bank_mask:0xf
    v_mul_f32_dpp v155, v181, v155 row_newbcast:5 row_mask:0xf bank_mask:0xf
    s_waitcnt lgkmcnt(7)
    v_mfma_f32_16x16x32_bf16 v[164:167], v[212:215], v[116:119], v[164:167]
    ds_read_b128 v[212:215], v7 offset:21504
    v_mul_f32_dpp v156, v180, v156 row_newbcast:6 row_mask:0xf bank_mask:0xf
    v_mul_f32_dpp v157, v181, v157 row_newbcast:6 row_mask:0xf bank_mask:0xf
    v_mul_f32_dpp v158, v180, v158 row_newbcast:7 row_mask:0xf bank_mask:0xf
    v_mul_f32_dpp v159, v181, v159 row_newbcast:7 row_mask:0xf bank_mask:0xf
    s_waitcnt lgkmcnt(7)
    v_mfma_f32_16x16x32_bf16 v[168:171], v[216:219], v[116:119], v[168:171]
    ds_read_b128 v[216:219], v7 offset:22528
    v_mul_f32_dpp v160, v180, v160 row_newbcast:8 row_mask:0xf bank_mask:0xf
    v_mul_f32_dpp v161, v181, v161 row_newbcast:8 row_mask:0xf bank_mask:0xf
    v_mul_f32_dpp v162, v180, v162 row_newbcast:9 row_mask:0xf bank_mask:0xf
    v_mul_f32_dpp v163, v181, v163 row_newbcast:9 row_mask:0xf bank_mask:0xf
    s_waitcnt lgkmcnt(7)
    v_mfma_f32_16x16x32_bf16 v[172:175], v[220:223], v[116:119], v[172:175]
    ds_read_b128 v[220:223], v7 offset:23552
    v_mul_f32_dpp v164, v180, v164 row_newbcast:10 row_mask:0xf bank_mask:0xf
    v_mul_f32_dpp v165, v181, v165 row_newbcast:10 row_mask:0xf bank_mask:0xf
    v_mul_f32_dpp v166, v180, v166 row_newbcast:11 row_mask:0xf bank_mask:0xf
    v_mul_f32_dpp v167, v181, v167 row_newbcast:11 row_mask:0xf bank_mask:0xf
    v_mul_f32_dpp v168, v180, v168 row_newbcast:12 row_mask:0xf bank_mask:0xf
    v_mul_f32_dpp v169, v181, v169 row_newbcast:12 row_mask:0xf bank_mask:0xf
    v_mul_f32_dpp v170, v180, v170 row_newbcast:13 row_mask:0xf bank_mask:0xf
    v_mul_f32_dpp v171, v181, v171 row_newbcast:13 row_mask:0xf bank_mask:0xf
    v_mul_f32_dpp v172, v180, v172 row_newbcast:14 row_mask:0xf bank_mask:0xf
    v_mul_f32_dpp v173, v181, v173 row_newbcast:14 row_mask:0xf bank_mask:0xf
    v_mul_f32_dpp v174, v180, v174 row_newbcast:15 row_mask:0xf bank_mask:0xf
    v_mul_f32_dpp v175, v181, v175 row_newbcast:15 row_mask:0xf bank_mask:0xf
    s_waitcnt lgkmcnt(7)
    v_mfma_f32_16x16x32_bf16 v[144:147], v[192:195], v[120:123], v[144:147]
    ds_read_b128 v[192:195], v7 offset:24576
    s_waitcnt lgkmcnt(7)
    v_mfma_f32_16x16x32_bf16 v[148:151], v[196:199], v[120:123], v[148:151]
    ds_read_b128 v[196:199], v7 offset:25600
    s_waitcnt lgkmcnt(7)
    v_mfma_f32_16x16x32_bf16 v[152:155], v[200:203], v[120:123], v[152:155]
    ds_read_b128 v[200:203], v7 offset:26624
    s_nop 0
    v_mul_f32_dpp v144, v182, v144 row_newbcast:0 row_mask:0xf bank_mask:0xf
    v_mul_f32_dpp v145, v183, v145 row_newbcast:0 row_mask:0xf bank_mask:0xf
    v_mul_f32_dpp v146, v182, v146 row_newbcast:1 row_mask:0xf bank_mask:0xf
    v_mul_f32_dpp v147, v183, v147 row_newbcast:1 row_mask:0xf bank_mask:0xf
    s_waitcnt lgkmcnt(7)
    v_mfma_f32_16x16x32_bf16 v[156:159], v[204:207], v[120:123], v[156:159]
    ds_read_b128 v[204:207], v7 offset:27648
    v_mul_f32_dpp v148, v182, v148 row_newbcast:2 row_mask:0xf bank_mask:0xf
    v_mul_f32_dpp v149, v183, v149 row_newbcast:2 row_mask:0xf bank_mask:0xf
    v_mul_f32_dpp v150, v182, v150 row_newbcast:3 row_mask:0xf bank_mask:0xf
    v_mul_f32_dpp v151, v183, v151 row_newbcast:3 row_mask:0xf bank_mask:0xf
    s_waitcnt lgkmcnt(7)
    v_mfma_f32_16x16x32_bf16 v[160:163], v[208:211], v[120:123], v[160:163]
    ds_read_b128 v[208:211], v7 offset:28672
    v_mul_f32_dpp v152, v182, v152 row_newbcast:4 row_mask:0xf bank_mask:0xf
    v_mul_f32_dpp v153, v183, v153 row_newbcast:4 row_mask:0xf bank_mask:0xf
    v_mul_f32_dpp v154, v182, v154 row_newbcast:5 row_mask:0xf bank_mask:0xf
    v_mul_f32_dpp v155, v183, v155 row_newbcast:5 row_mask:0xf bank_mask:0xf
    s_waitcnt lgkmcnt(7)
    v_mfma_f32_16x16x32_bf16 v[164:167], v[212:215], v[120:123], v[164:167]
    ds_read_b128 v[212:215], v7 offset:29696
    v_mul_f32_dpp v156, v182, v156 row_newbcast:6 row_mask:0xf bank_mask:0xf
    v_mul_f32_dpp v157, v183, v157 row_newbcast:6 row_mask:0xf bank_mask:0xf
    v_mul_f32_dpp v158, v182, v158 row_newbcast:7 row_mask:0xf bank_mask:0xf
    v_mul_f32_dpp v159, v183, v159 row_newbcast:7 row_mask:0xf bank_mask:0xf
    s_waitcnt lgkmcnt(7)
    v_mfma_f32_16x16x32_bf16 v[168:171], v[216:219], v[120:123], v[168:171]
    ds_read_b128 v[216:219], v7 offset:30720
    v_mul_f32_dpp v160, v182, v160 row_newbcast:8 row_mask:0xf bank_mask:0xf
    v_mul_f32_dpp v161, v183, v161 row_newbcast:8 row_mask:0xf bank_mask:0xf
    v_mul_f32_dpp v162, v182, v162 row_newbcast:9 row_mask:0xf bank_mask:0xf
    v_mul_f32_dpp v163, v183, v163 row_newbcast:9 row_mask:0xf bank_mask:0xf
    s_waitcnt lgkmcnt(7)
    v_mfma_f32_16x16x32_bf16 v[172:175], v[220:223], v[120:123], v[172:175]
    ds_read_b128 v[220:223], v7 offset:31744
    v_mul_f32_dpp v164, v182, v164 row_newbcast:10 row_mask:0xf bank_mask:0xf
    v_mul_f32_dpp v165, v183, v165 row_newbcast:10 row_mask:0xf bank_mask:0xf
    v_mul_f32_dpp v166, v182, v166 row_newbcast:11 row_mask:0xf bank_mask:0xf
    v_mul_f32_dpp v167, v183, v167 row_newbcast:11 row_mask:0xf bank_mask:0xf
    v_mul_f32_dpp v168, v182, v168 row_newbcast:12 row_mask:0xf bank_mask:0xf
    v_mul_f32_dpp v169, v183, v169 row_newbcast:12 row_mask:0xf bank_mask:0xf
    v_mul_f32_dpp v170, v182, v170 row_newbcast:13 row_mask:0xf bank_mask:0xf
    v_mul_f32_dpp v171, v183, v171 row_newbcast:13 row_mask:0xf bank_mask:0xf
    v_mul_f32_dpp v172, v182, v172 row_newbcast:14 row_mask:0xf bank_mask:0xf
    v_mul_f32_dpp v173, v183, v173 row_newbcast:14 row_mask:0xf bank_mask:0xf
    v_mul_f32_dpp v174, v182, v174 row_newbcast:15 row_mask:0xf bank_mask:0xf
    v_mul_f32_dpp v175, v183, v175 row_newbcast:15 row_mask:0xf bank_mask:0xf
    s_waitcnt lgkmcnt(7)
    v_mfma_f32_16x16x32_bf16 v[144:147], v[192:195], v[124:127], v[144:147]
    ds_read_b128 v[192:195], v7 offset:32768
    s_waitcnt lgkmcnt(7)
    v_mfma_f32_16x16x32_bf16 v[148:151], v[196:199], v[124:127], v[148:151]
    ds_read_b128 v[196:199], v7 offset:33792
    s_waitcnt lgkmcnt(7)
    v_mfma_f32_16x16x32_bf16 v[152:155], v[200:203], v[124:127], v[152:155]
    ds_read_b128 v[200:203], v7 offset:34816
    s_nop 0
    v_mul_f32_dpp v144, v184, v144 row_newbcast:0 row_mask:0xf bank_mask:0xf
    v_mul_f32_dpp v145, v185, v145 row_newbcast:0 row_mask:0xf bank_mask:0xf
    v_mul_f32_dpp v146, v184, v146 row_newbcast:1 row_mask:0xf bank_mask:0xf
    v_mul_f32_dpp v147, v185, v147 row_newbcast:1 row_mask:0xf bank_mask:0xf
    s_waitcnt lgkmcnt(7)
    v_mfma_f32_16x16x32_bf16 v[156:159], v[204:207], v[124:127], v[156:159]
    ds_read_b128 v[204:207], v7 offset:35840
    v_mul_f32_dpp v148, v184, v148 row_newbcast:2 row_mask:0xf bank_mask:0xf
    v_mul_f32_dpp v149, v185, v149 row_newbcast:2 row_mask:0xf bank_mask:0xf
    v_mul_f32_dpp v150, v184, v150 row_newbcast:3 row_mask:0xf bank_mask:0xf
    v_mul_f32_dpp v151, v185, v151 row_newbcast:3 row_mask:0xf bank_mask:0xf
    s_waitcnt lgkmcnt(7)
    v_mfma_f32_16x16x32_bf16 v[160:163], v[208:211], v[124:127], v[160:163]
    ds_read_b128 v[208:211], v7 offset:36864
    v_mul_f32_dpp v152, v184, v152 row_newbcast:4 row_mask:0xf bank_mask:0xf
    v_mul_f32_dpp v153, v185, v153 row_newbcast:4 row_mask:0xf bank_mask:0xf
    v_mul_f32_dpp v154, v184, v154 row_newbcast:5 row_mask:0xf bank_mask:0xf
    v_mul_f32_dpp v155, v185, v155 row_newbcast:5 row_mask:0xf bank_mask:0xf
    s_waitcnt lgkmcnt(7)
    v_mfma_f32_16x16x32_bf16 v[164:167], v[212:215], v[124:127], v[164:167]
    ds_read_b128 v[212:215], v7 offset:37888
    v_mul_f32_dpp v156, v184, v156 row_newbcast:6 row_mask:0xf bank_mask:0xf
    v_mul_f32_dpp v157, v185, v157 row_newbcast:6 row_mask:0xf bank_mask:0xf
    v_mul_f32_dpp v158, v184, v158 row_newbcast:7 row_mask:0xf bank_mask:0xf
    v_mul_f32_dpp v159, v185, v159 row_newbcast:7 row_mask:0xf bank_mask:0xf
    s_waitcnt lgkmcnt(7)
    v_mfma_f32_16x16x32_bf16 v[168:171], v[216:219], v[124:127], v[168:171]
    ds_read_b128 v[216:219], v7 offset:38912
    v_mul_f32_dpp v160, v184, v160 row_newbcast:8 row_mask:0xf bank_mask:0xf
    v_mul_f32_dpp v161, v185, v161 row_newbcast:8 row_mask:0xf bank_mask:0xf
    v_mul_f32_dpp v162, v184, v162 row_newbcast:9 row_mask:0xf bank_mask:0xf
    v_mul_f32_dpp v163, v185, v163 row_newbcast:9 row_mask:0xf bank_mask:0xf
    s_waitcnt lgkmcnt(7)
    v_mfma_f32_16x16x32_bf16 v[172:175], v[220:223], v[124:127], v[172:175]
    ds_read_b128 v[220:223], v7 offset:39936
    v_mul_f32_dpp v164, v184, v164 row_newbcast:10 row_mask:0xf bank_mask:0xf
    v_mul_f32_dpp v165, v185, v165 row_newbcast:10 row_mask:0xf bank_mask:0xf
    v_mul_f32_dpp v166, v184, v166 row_newbcast:11 row_mask:0xf bank_mask:0xf
    v_mul_f32_dpp v167, v185, v167 row_newbcast:11 row_mask:0xf bank_mask:0xf
    v_mul_f32_dpp v168, v184, v168 row_newbcast:12 row_mask:0xf bank_mask:0xf
    v_mul_f32_dpp v169, v185, v169 row_newbcast:12 row_mask:0xf bank_mask:0xf
    v_mul_f32_dpp v170, v184, v170 row_newbcast:13 row_mask:0xf bank_mask:0xf
    v_mul_f32_dpp v171, v185, v171 row_newbcast:13 row_mask:0xf bank_mask:0xf
    v_mul_f32_dpp v172, v184, v172 row_newbcast:14 row_mask:0xf bank_mask:0xf
    v_mul_f32_dpp v173, v185, v173 row_newbcast:14 row_mask:0xf bank_mask:0xf
    v_mul_f32_dpp v174, v184, v174 row_newbcast:15 row_mask:0xf bank_mask:0xf
    v_mul_f32_dpp v175, v185, v175 row_newbcast:15 row_mask:0xf bank_mask:0xf
    s_waitcnt lgkmcnt(7)
    v_mfma_f32_16x16x32_bf16 v[144:147], v[192:195], v[128:131], v[144:147]
    ds_read_b128 v[192:195], v7 offset:40960
    s_waitcnt lgkmcnt(7)
    v_mfma_f32_16x16x32_bf16 v[148:151], v[196:199], v[128:131], v[148:151]
    ds_read_b128 v[196:199], v7 offset:41984
    s_waitcnt lgkmcnt(7)
    v_mfma_f32_16x16x32_bf16 v[152:155], v[200:203], v[128:131], v[152:155]
    ds_read_b128 v[200:203], v7 offset:43008
    s_nop 0
    v_mul_f32_dpp v144, v186, v144 row_newbcast:0 row_mask:0xf bank_mask:0xf
    v_mul_f32_dpp v145, v187, v145 row_newbcast:0 row_mask:0xf bank_mask:0xf
    v_mul_f32_dpp v146, v186, v146 row_newbcast:1 row_mask:0xf bank_mask:0xf
    v_mul_f32_dpp v147, v187, v147 row_newbcast:1 row_mask:0xf bank_mask:0xf
    s_waitcnt lgkmcnt(7)
    v_mfma_f32_16x16x32_bf16 v[156:159], v[204:207], v[128:131], v[156:159]
    ds_read_b128 v[204:207], v7 offset:44032
    v_mul_f32_dpp v148, v186, v148 row_newbcast:2 row_mask:0xf bank_mask:0xf
    v_mul_f32_dpp v149, v187, v149 row_newbcast:2 row_mask:0xf bank_mask:0xf
    v_mul_f32_dpp v150, v186, v150 row_newbcast:3 row_mask:0xf bank_mask:0xf
    v_mul_f32_dpp v151, v187, v151 row_newbcast:3 row_mask:0xf bank_mask:0xf
    s_waitcnt lgkmcnt(7)
    v_mfma_f32_16x16x32_bf16 v[160:163], v[208:211], v[128:131], v[160:163]
    ds_read_b128 v[208:211], v7 offset:45056
    v_mul_f32_dpp v152, v186, v152 row_newbcast:4 row_mask:0xf bank_mask:0xf
    v_mul_f32_dpp v153, v187, v153 row_newbcast:4 row_mask:0xf bank_mask:0xf
    v_mul_f32_dpp v154, v186, v154 row_newbcast:5 row_mask:0xf bank_mask:0xf
    v_mul_f32_dpp v155, v187, v155 row_newbcast:5 row_mask:0xf bank_mask:0xf
    s_waitcnt lgkmcnt(7)
    v_mfma_f32_16x16x32_bf16 v[164:167], v[212:215], v[128:131], v[164:167]
    ds_read_b128 v[212:215], v7 offset:46080
    v_mul_f32_dpp v156, v186, v156 row_newbcast:6 row_mask:0xf bank_mask:0xf
    v_mul_f32_dpp v157, v187, v157 row_newbcast:6 row_mask:0xf bank_mask:0xf
    v_mul_f32_dpp v158, v186, v158 row_newbcast:7 row_mask:0xf bank_mask:0xf
    v_mul_f32_dpp v159, v187, v159 row_newbcast:7 row_mask:0xf bank_mask:0xf
    s_waitcnt lgkmcnt(7)
    v_mfma_f32_16x16x32_bf16 v[168:171], v[216:219], v[128:131], v[168:171]
    ds_read_b128 v[216:219], v7 offset:47104
    v_mul_f32_dpp v160, v186, v160 row_newbcast:8 row_mask:0xf bank_mask:0xf
    v_mul_f32_dpp v161, v187, v161 row_newbcast:8 row_mask:0xf bank_mask:0xf
    v_mul_f32_dpp v162, v186, v162 row_newbcast:9 row_mask:0xf bank_mask:0xf
    v_mul_f32_dpp v163, v187, v163 row_newbcast:9 row_mask:0xf bank_mask:0xf
    s_waitcnt lgkmcnt(7)
    v_mfma_f32_16x16x32_bf16 v[172:175], v[220:223], v[128:131], v[172:175]
    ds_read_b128 v[220:223], v7 offset:48128
    v_mul_f32_dpp v164, v186, v164 row_newbcast:10 row_mask:0xf bank_mask:0xf
    v_mul_f32_dpp v165, v187, v165 row_newbcast:10 row_mask:0xf bank_mask:0xf
    v_mul_f32_dpp v166, v186, v166 row_newbcast:11 row_mask:0xf bank_mask:0xf
    v_mul_f32_dpp v167, v187, v167 row_newbcast:11 row_mask:0xf bank_mask:0xf
    v_mul_f32_dpp v168, v186, v168 row_newbcast:12 row_mask:0xf bank_mask:0xf
    v_mul_f32_dpp v169, v187, v169 row_newbcast:12 row_mask:0xf bank_mask:0xf
    v_mul_f32_dpp v170, v186, v170 row_newbcast:13 row_mask:0xf bank_mask:0xf
    v_mul_f32_dpp v171, v187, v171 row_newbcast:13 row_mask:0xf bank_mask:0xf
    v_mul_f32_dpp v172, v186, v172 row_newbcast:14 row_mask:0xf bank_mask:0xf
    v_mul_f32_dpp v173, v187, v173 row_newbcast:14 row_mask:0xf bank_mask:0xf
    v_mul_f32_dpp v174, v186, v174 row_newbcast:15 row_mask:0xf bank_mask:0xf
    v_mul_f32_dpp v175, v187, v175 row_newbcast:15 row_mask:0xf bank_mask:0xf
    s_waitcnt lgkmcnt(7)
    v_mfma_f32_16x16x32_bf16 v[144:147], v[192:195], v[132:135], v[144:147]
    ds_read_b128 v[192:195], v7 offset:49152
    s_waitcnt lgkmcnt(7)
    v_mfma_f32_16x16x32_bf16 v[148:151], v[196:199], v[132:135], v[148:151]
    ds_read_b128 v[196:199], v7 offset:50176
    s_waitcnt lgkmcnt(7)
    v_mfma_f32_16x16x32_bf16 v[152:155], v[200:203], v[132:135], v[152:155]
    ds_read_b128 v[200:203], v7 offset:51200
    s_nop 0
    v_mul_f32_dpp v144, v188, v144 row_newbcast:0 row_mask:0xf bank_mask:0xf
    v_mul_f32_dpp v145, v189, v145 row_newbcast:0 row_mask:0xf bank_mask:0xf
    v_mul_f32_dpp v146, v188, v146 row_newbcast:1 row_mask:0xf bank_mask:0xf
    v_mul_f32_dpp v147, v189, v147 row_newbcast:1 row_mask:0xf bank_mask:0xf
    s_waitcnt lgkmcnt(7)
    v_mfma_f32_16x16x32_bf16 v[156:159], v[204:207], v[132:135], v[156:159]
    ds_read_b128 v[204:207], v7 offset:52224
    v_mul_f32_dpp v148, v188, v148 row_newbcast:2 row_mask:0xf bank_mask:0xf
    v_mul_f32_dpp v149, v189, v149 row_newbcast:2 row_mask:0xf bank_mask:0xf
    v_mul_f32_dpp v150, v188, v150 row_newbcast:3 row_mask:0xf bank_mask:0xf
    v_mul_f32_dpp v151, v189, v151 row_newbcast:3 row_mask:0xf bank_mask:0xf
    s_waitcnt lgkmcnt(7)
    v_mfma_f32_16x16x32_bf16 v[160:163], v[208:211], v[132:135], v[160:163]
    ds_read_b128 v[208:211], v7 offset:53248
    v_mul_f32_dpp v152, v188, v152 row_newbcast:4 row_mask:0xf bank_mask:0xf
    v_mul_f32_dpp v153, v189, v153 row_newbcast:4 row_mask:0xf bank_mask:0xf
    v_mul_f32_dpp v154, v188, v154 row_newbcast:5 row_mask:0xf bank_mask:0xf
    v_mul_f32_dpp v155, v189, v155 row_newbcast:5 row_mask:0xf bank_mask:0xf
    s_waitcnt lgkmcnt(7)
    v_mfma_f32_16x16x32_bf16 v[164:167], v[212:215], v[132:135], v[164:167]
    ds_read_b128 v[212:215], v7 offset:54272
    v_mul_f32_dpp v156, v188, v156 row_newbcast:6 row_mask:0xf bank_mask:0xf
    v_mul_f32_dpp v157, v189, v157 row_newbcast:6 row_mask:0xf bank_mask:0xf
    v_mul_f32_dpp v158, v188, v158 row_newbcast:7 row_mask:0xf bank_mask:0xf
    v_mul_f32_dpp v159, v189, v159 row_newbcast:7 row_mask:0xf bank_mask:0xf
    s_waitcnt lgkmcnt(7)
    v_mfma_f32_16x16x32_bf16 v[168:171], v[216:219], v[132:135], v[168:171]
    ds_read_b128 v[216:219], v7 offset:55296
    v_mul_f32_dpp v160, v188, v160 row_newbcast:8 row_mask:0xf bank_mask:0xf
    v_mul_f32_dpp v161, v189, v161 row_newbcast:8 row_mask:0xf bank_mask:0xf
    v_mul_f32_dpp v162, v188, v162 row_newbcast:9 row_mask:0xf bank_mask:0xf
    v_mul_f32_dpp v163, v189, v163 row_newbcast:9 row_mask:0xf bank_mask:0xf
    s_waitcnt lgkmcnt(7)
    v_mfma_f32_16x16x32_bf16 v[172:175], v[220:223], v[132:135], v[172:175]
    ds_read_b128 v[220:223], v7 offset:56320
    v_mul_f32_dpp v164, v188, v164 row_newbcast:10 row_mask:0xf bank_mask:0xf
    v_mul_f32_dpp v165, v189, v165 row_newbcast:10 row_mask:0xf bank_mask:0xf
    v_mul_f32_dpp v166, v188, v166 row_newbcast:11 row_mask:0xf bank_mask:0xf
    v_mul_f32_dpp v167, v189, v167 row_newbcast:11 row_mask:0xf bank_mask:0xf
    v_mul_f32_dpp v168, v188, v168 row_newbcast:12 row_mask:0xf bank_mask:0xf
    v_mul_f32_dpp v169, v189, v169 row_newbcast:12 row_mask:0xf bank_mask:0xf
    v_mul_f32_dpp v170, v188, v170 row_newbcast:13 row_mask:0xf bank_mask:0xf
    v_mul_f32_dpp v171, v189, v171 row_newbcast:13 row_mask:0xf bank_mask:0xf
    v_mul_f32_dpp v172, v188, v172 row_newbcast:14 row_mask:0xf bank_mask:0xf
    v_mul_f32_dpp v173, v189, v173 row_newbcast:14 row_mask:0xf bank_mask:0xf
    v_mul_f32_dpp v174, v188, v174 row_newbcast:15 row_mask:0xf bank_mask:0xf
    v_mul_f32_dpp v175, v189, v175 row_newbcast:15 row_mask:0xf bank_mask:0xf
    s_waitcnt lgkmcnt(7)
    v_mfma_f32_16x16x32_bf16 v[144:147], v[192:195], v[136:139], v[144:147]
    ds_read_b128 v[192:195], v7 offset:57344
    s_waitcnt lgkmcnt(7)
    v_mfma_f32_16x16x32_bf16 v[148:151], v[196:199], v[136:139], v[148:151]
    ds_read_b128 v[196:199], v7 offset:58368
    s_waitcnt lgkmcnt(7)
    v_mfma_f32_16x16x32_bf16 v[152:155], v[200:203], v[136:139], v[152:155]
    ds_read_b128 v[200:203], v7 offset:59392
    s_nop 0
    v_mul_f32_dpp v144, v190, v144 row_newbcast:0 row_mask:0xf bank_mask:0xf
    v_mul_f32_dpp v145, v191, v145 row_newbcast:0 row_mask:0xf bank_mask:0xf
    v_mul_f32_dpp v146, v190, v146 row_newbcast:1 row_mask:0xf bank_mask:0xf
    v_mul_f32_dpp v147, v191, v147 row_newbcast:1 row_mask:0xf bank_mask:0xf
    s_waitcnt lgkmcnt(7)
    v_mfma_f32_16x16x32_bf16 v[156:159], v[204:207], v[136:139], v[156:159]
    ds_read_b128 v[204:207], v7 offset:60416
    v_mul_f32_dpp v148, v190, v148 row_newbcast:2 row_mask:0xf bank_mask:0xf
    v_mul_f32_dpp v149, v191, v149 row_newbcast:2 row_mask:0xf bank_mask:0xf
    v_mul_f32_dpp v150, v190, v150 row_newbcast:3 row_mask:0xf bank_mask:0xf
    v_mul_f32_dpp v151, v191, v151 row_newbcast:3 row_mask:0xf bank_mask:0xf
    s_waitcnt lgkmcnt(7)
    v_mfma_f32_16x16x32_bf16 v[160:163], v[208:211], v[136:139], v[160:163]
    ds_read_b128 v[208:211], v7 offset:61440
    v_mul_f32_dpp v152, v190, v152 row_newbcast:4 row_mask:0xf bank_mask:0xf
    v_mul_f32_dpp v153, v191, v153 row_newbcast:4 row_mask:0xf bank_mask:0xf
    v_mul_f32_dpp v154, v190, v154 row_newbcast:5 row_mask:0xf bank_mask:0xf
    v_mul_f32_dpp v155, v191, v155 row_newbcast:5 row_mask:0xf bank_mask:0xf
    s_waitcnt lgkmcnt(7)
    v_mfma_f32_16x16x32_bf16 v[164:167], v[212:215], v[136:139], v[164:167]
    ds_read_b128 v[212:215], v7 offset:62464
    v_mul_f32_dpp v156, v190, v156 row_newbcast:6 row_mask:0xf bank_mask:0xf
    v_mul_f32_dpp v157, v191, v157 row_newbcast:6 row_mask:0xf bank_mask:0xf
    v_mul_f32_dpp v158, v190, v158 row_newbcast:7 row_mask:0xf bank_mask:0xf
    v_mul_f32_dpp v159, v191, v159 row_newbcast:7 row_mask:0xf bank_mask:0xf
    s_waitcnt lgkmcnt(7)
    v_mfma_f32_16x16x32_bf16 v[168:171], v[216:219], v[136:139], v[168:171]
    ds_read_b128 v[216:219], v7 offset:63488
    v_mul_f32_dpp v160, v190, v160 row_newbcast:8 row_mask:0xf bank_mask:0xf
    v_mul_f32_dpp v161, v191, v161 row_newbcast:8 row_mask:0xf bank_mask:0xf
    v_mul_f32_dpp v162, v190, v162 row_newbcast:9 row_mask:0xf bank_mask:0xf
    v_mul_f32_dpp v163, v191, v163 row_newbcast:9 row_mask:0xf bank_mask:0xf
    s_waitcnt lgkmcnt(7)
    v_mfma_f32_16x16x32_bf16 v[172:175], v[220:223], v[136:139], v[172:175]
    ds_read_b128 v[220:223], v7 offset:64512
    v_mul_f32_dpp v164, v190, v164 row_newbcast:10 row_mask:0xf bank_mask:0xf
    v_mul_f32_dpp v165, v191, v165 row_newbcast:10 row_mask:0xf bank_mask:0xf
    v_mul_f32_dpp v166, v190, v166 row_newbcast:11 row_mask:0xf bank_mask:0xf
    v_mul_f32_dpp v167, v191, v167 row_newbcast:11 row_mask:0xf bank_mask:0xf
    v_mul_f32_dpp v168, v190, v168 row_newbcast:12 row_mask:0xf bank_mask:0xf
    v_mul_f32_dpp v169, v191, v169 row_newbcast:12 row_mask:0xf bank_mask:0xf
    v_mul_f32_dpp v170, v190, v170 row_newbcast:13 row_mask:0xf bank_mask:0xf
    v_mul_f32_dpp v171, v191, v171 row_newbcast:13 row_mask:0xf bank_mask:0xf
    v_mul_f32_dpp v172, v190, v172 row_newbcast:14 row_mask:0xf bank_mask:0xf
    v_mul_f32_dpp v173, v191, v173 row_newbcast:14 row_mask:0xf bank_mask:0xf
    v_mul_f32_dpp v174, v190, v174 row_newbcast:15 row_mask:0xf bank_mask:0xf
    v_mul_f32_dpp v175, v191, v175 row_newbcast:15 row_mask:0xf bank_mask:0xf
    s_waitcnt lgkmcnt(7)
    v_mfma_f32_16x16x32_bf16 v[144:147], v[192:195], v[140:143], v[144:147]
    s_waitcnt lgkmcnt(6)
    v_mfma_f32_16x16x32_bf16 v[148:151], v[196:199], v[140:143], v[148:151]
    s_waitcnt lgkmcnt(5)
    v_mfma_f32_16x16x32_bf16 v[152:155], v[200:203], v[140:143], v[152:155]
    s_waitcnt lgkmcnt(4)
    v_mfma_f32_16x16x32_bf16 v[156:159], v[204:207], v[140:143], v[156:159]
    s_waitcnt lgkmcnt(3)
    v_mfma_f32_16x16x32_bf16 v[160:163], v[208:211], v[140:143], v[160:163]
    s_waitcnt lgkmcnt(2)
    v_mfma_f32_16x16x32_bf16 v[164:167], v[212:215], v[140:143], v[164:167]
    s_waitcnt lgkmcnt(1)
    v_mfma_f32_16x16x32_bf16 v[168:171], v[216:219], v[140:143], v[168:171]
    s_waitcnt lgkmcnt(0)
    v_mfma_f32_16x16x32_bf16 v[172:175], v[220:223], v[140:143], v[172:175]
    s_nop 12
    s_branch L_fullA_ret
    s_nop 12
L_end:
    s_endpgm
.section .rodata,"a"
.p2align 6
.amdhsa_kernel standalone__gated_linear_recurrence__prompt_kernel
  .amdhsa_next_free_vgpr 256
  .amdhsa_next_free_sgpr 102
  .amdhsa_accum_offset 256
  .amdhsa_group_segment_fixed_size 0
  .amdhsa_kernarg_size 56
  .amdhsa_user_sgpr_count 2
  .amdhsa_user_sgpr_kernarg_segment_ptr 1
  .amdhsa_system_sgpr_workgroup_id_x 1
.end_amdhsa_kernel
```
